```python
import torch

def _softmax(x, axis=-1):
    return torch.softmax(x, dim=axis)
def _gelu(x):
    return torch.nn.functional.gelu(x, approximate="tanh")
def _silu(x):
    return torch.nn.functional.silu(x)
def _sigmoid(x):
    return torch.sigmoid(x)
def _layernorm(x, axis=-1, eps=1e-5):
    m = x.mean(dim=axis, keepdim=True)
    v = x.var(dim=axis, keepdim=True, unbiased=False)
    return (x - m) / torch.sqrt(v + eps)
def _scatter_add(tgt, idx, src, axis=0):
    return tgt.clone().index_add_(axis, idx, src)
def _segment_sum(src, seg, n):
    out = torch.zeros((n,) + src.shape[1:], dtype=src.dtype)
    return out.index_add_(0, seg, src)
def _pad(x, pw):
    flat = tuple(v for pair in reversed(pw) for v in pair)
    return torch.nn.functional.pad(x, flat)

kernel_name = 'sequential_preLN__ssm_conv_h3__moe_arch_mod__prompt'

def setup_inputs():

    _w = (lambda a: (lambda t: t.to(torch.bfloat16) if t.is_floating_point() else t)(torch.as_tensor(a)))
    def _A_setup():
        B, S, D = 1, 2048, 640
        ks = 4
        return {
            "q": _w((lambda *s: torch.randn(*s, dtype=torch.bfloat16) * 0.05)(B, S, D)),
            "k": _w((lambda *s: torch.randn(*s, dtype=torch.bfloat16) * 0.2)(B, S, D)),
            "v": _w((lambda *s: torch.randn(*s, dtype=torch.bfloat16) * 0.2)(B, S, D)),
            "shift_k": _w((lambda *s: torch.randn(*s, dtype=torch.bfloat16) * 0.2)(D, ks) * 0.5),
            "ssm_k": _w((lambda *s: torch.randn(*s, dtype=torch.bfloat16) * 0.8)(D, S) * (1.0 / S ** 0.5)),
            "ssm_D": _w((lambda *s: torch.randn(*s, dtype=torch.bfloat16) * 0.2)(D)),
        }
    _A_in = _A_setup()

    def _B_setup():
        B, S, D, F, C = 1, 2048, 640, 1728, 8
        return {
            "x": _w((lambda *s: torch.randn(*s, dtype=torch.bfloat16) * 0.05)(B, S, D)),
            "w_r": _w((lambda *s: torch.randn(*s, dtype=torch.bfloat16) * 0.05)(D)),
            "w_gate": _w((lambda *s: torch.randn(*s, dtype=torch.bfloat16) * 0.05)(D, F)),
            "w_up": _w((lambda *s: torch.randn(*s, dtype=torch.bfloat16) * 0.05)(D, F)),
            "w_down": _w((lambda *s: torch.randn(*s, dtype=torch.bfloat16) * 0.05)(F, D)),
        }
    _B_in = _B_setup()

    return {
        "A_q": _A_in["q"],
        "A_k": _A_in["k"],
        "A_v": _A_in["v"],
        "A_shift_k": _A_in["shift_k"],
        "A_ssm_k": _A_in["ssm_k"],
        "A_ssm_D": _A_in["ssm_D"],
        "B_x": _B_in["x"],
        "B_w_r": _B_in["w_r"],
        "B_w_gate": _B_in["w_gate"],
        "B_w_up": _B_in["w_up"],
        "B_w_down": _B_in["w_down"],
    }

def reference(A_q, A_k, A_v, A_shift_k, A_ssm_k, A_ssm_D, B_x, B_w_r, B_w_gate, B_w_up, B_w_down):
    def _A_ref(q, k, v, shift_k, ssm_k, ssm_D):
        B, S, D = q.shape
        ks = shift_k.shape[-1]
        k_pad = _pad(k, ((0, 0), (ks - 1, 0), (0, 0)))
        k_shift = torch.zeros_like(k)
        for t in range(ks):
            k_shift = k_shift + k_pad[:, t:t + S, :] * shift_k[:, ks - 1 - t][None, None, :]
        kv = k_shift * v
        L = 2 * S
        kv_pad = _pad(kv, ((0, 0), (0, S), (0, 0)))
        kf_pad = _pad(ssm_k, ((0, 0), (0, S)))
        kv_f = (lambda x, axes=(-2,-1): torch.fft.rfft2(x.float(), dim=axes))(kv_pad[:, None, :, :], axes=(1, 2))
        kf_f = (lambda x, axes=(-2,-1): torch.fft.rfft2(x.float(), dim=axes))(kf_pad[:, None, :], axes=(1, 2))
        kf_f = (lambda x, *d: x.permute(*d))(kf_f, 1, 2, 0)
        y_f = kv_f * kf_f[None, :, :, :]
        y = (lambda x, s, axes=(-2,-1): torch.fft.irfft2(x, s=s, dim=axes).to(torch.bfloat16))(y_f, (1, L), axes=(1, 2))[:, 0, :S, :]
        y = y + kv * ssm_D[None, None, :]
        return q * y

    def _B_ref(x, w_r, w_gate, w_up, w_down):
        B, S, D = x.shape
        C = 8
        r = x @ w_r
        idx = torch.argsort(-r, axis=-1)[:, :C]
        idx_e = (lambda x, n, axis: torch.repeat_interleave(x, n, dim=axis))(idx.reshape(B, C, 1), D, axis=2)
        x_sel = (lambda x, i, axis: torch.take_along_dim(x, i, dim=axis))(x, idx_e, axis=1)
        g = _silu(x_sel @ w_gate)
        u = x_sel @ w_up
        y = (g * u) @ w_down
        r_sel = _sigmoid((lambda x, i, axis: torch.take_along_dim(x, i, dim=axis))(r, idx, axis=1))
        y = y * r_sel.reshape(B, C, 1)
        b_off = (torch.arange(B) * S).reshape(B, 1)
        flat_idx = (idx + b_off).reshape(B * C)
        zero = (x * 0.0).reshape(B * S, D)
        upd = _scatter_add(zero, flat_idx, y.reshape(B * C, D), axis=0)
        return x + upd.reshape(B, S, D)

    x = A_q
    h = x + _A_ref(_layernorm(x, axis=-1), A_k, A_v, A_shift_k, A_ssm_k, A_ssm_D)
    h2 = h + _B_ref(_layernorm(h, axis=-1), B_w_r, B_w_gate, B_w_up, B_w_down)
    return h2
```

```asm
; @launch kernel=k0_kernel grid=(320,1,1) block=(256,1,1) lds=9216
; @launch kernel=k1_kernel grid=(640,1,1) block=(256,1,1) lds=38656
; @launch kernel=k2_kernel grid=(512,1,1) block=(256,1,1) lds=0
; @launch kernel=k3_kernel grid=(54,1,1) block=(512,1,1) lds=17920
.amdgcn_target "amdgcn-amd-amdhsa--gfx950"
.text
.globl k0_kernel
.p2align 8
.type k0_kernel,@function
k0_kernel:
  s_cmp_ge_u32 s2, 320
  s_cbranch_scc1 k0_done
  s_load_dwordx4 s[4:7], s[0:1], 8
  s_load_dwordx2 s[24:25], s[0:1], 24
  s_load_dwordx2 s[26:27], s[0:1], 104
  s_mov_b32 s28, 0x1999999A
  s_mul_hi_u32 s29, s2, s28
  s_mul_i32 s30, s29, 10
  s_sub_u32 s30, s2, s30
  v_and_b32 v1, 7, v0
  v_lshrrev_b32 v2, 3, v0
  s_lshl_b32 s31, s29, 6
  v_lshlrev_b32 v3, 1, v2
  v_add_u32 v3, s31, v3
  s_movk_i32 s33, 1280
  v_mul_lo_u32 v3, v3, s33
  s_lshl_b32 s32, s30, 7
  v_lshlrev_b32 v4, 4, v1
  v_add3_u32 v3, v3, s32, v4
  v_add_u32 v10, -3840, v3
  v_add_u32 v11, -2560, v3
  v_add_u32 v12, -1280, v3
  v_add_u32 v13, 0, v3
  v_add_u32 v14, 1280, v3
  s_lshl_b32 s34, s30, 9
  v_lshlrev_b32 v5, 6, v1
  v_add_u32 v5, s34, v5
  s_waitcnt lgkmcnt(0)
  s_mov_b32 s8, s4
  s_mov_b32 s9, s5
  s_mov_b32 s10, 0x280000
  s_mov_b32 s11, 0x00020000
  s_mov_b32 s12, s6
  s_mov_b32 s13, s7
  s_mov_b32 s14, 0x280000
  s_mov_b32 s15, 0x00020000
  s_mov_b32 s16, s24
  s_mov_b32 s17, s25
  s_mov_b32 s18, 0x1400
  s_mov_b32 s19, 0x00020000
  s_mov_b32 s20, s26
  s_mov_b32 s21, s27
  s_mov_b32 s22, 0x2a8000
  s_mov_b32 s23, 0x00020000
  buffer_load_dwordx4 v[20:23], v10, s[8:11], 0 offen
  buffer_load_dwordx4 v[24:27], v11, s[8:11], 0 offen
  buffer_load_dwordx4 v[28:31], v12, s[8:11], 0 offen
  buffer_load_dwordx4 v[32:35], v13, s[8:11], 0 offen
  buffer_load_dwordx4 v[36:39], v14, s[8:11], 0 offen
  buffer_load_dwordx4 v[40:43], v3, s[12:15], 0 offen
  buffer_load_dwordx4 v[44:47], v3, s[12:15], 0 offen offset:1280
  buffer_load_dwordx4 v[48:51], v5, s[16:19], 0 offen offset:0
  buffer_load_dwordx4 v[52:55], v5, s[16:19], 0 offen offset:16
  buffer_load_dwordx4 v[56:59], v5, s[16:19], 0 offen offset:32
  buffer_load_dwordx4 v[60:63], v5, s[16:19], 0 offen offset:48
  v_lshrrev_b32 v6, 2, v2
  v_lshlrev_b32 v6, 2, v6
  v_and_b32 v7, 3, v2
  v_sub_u32 v7, 3, v7
  v_add_u32 v6, v6, v7
  v_lshlrev_b32 v6, 2, v6
  s_movk_i32 s35, 1152
  v_mul_lo_u32 v7, v1, s35
  v_add_u32 v6, v6, v7
  s_waitcnt vmcnt(0)
  v_lshlrev_b32 v64, 16, v48
  v_and_b32 v65, 0xffff0000, v48
  v_lshlrev_b32 v66, 16, v49
  v_and_b32 v67, 0xffff0000, v49
  v_lshlrev_b32 v68, 16, v50
  v_and_b32 v69, 0xffff0000, v50
  v_lshlrev_b32 v70, 16, v51
  v_and_b32 v71, 0xffff0000, v51
  v_lshlrev_b32 v72, 16, v52
  v_and_b32 v73, 0xffff0000, v52
  v_lshlrev_b32 v74, 16, v53
  v_and_b32 v75, 0xffff0000, v53
  v_lshlrev_b32 v76, 16, v54
  v_and_b32 v77, 0xffff0000, v54
  v_lshlrev_b32 v78, 16, v55
  v_and_b32 v79, 0xffff0000, v55
  v_lshlrev_b32 v80, 16, v56
  v_and_b32 v81, 0xffff0000, v56
  v_lshlrev_b32 v82, 16, v57
  v_and_b32 v83, 0xffff0000, v57
  v_lshlrev_b32 v84, 16, v58
  v_and_b32 v85, 0xffff0000, v58
  v_lshlrev_b32 v86, 16, v59
  v_and_b32 v87, 0xffff0000, v59
  v_lshlrev_b32 v88, 16, v60
  v_and_b32 v89, 0xffff0000, v60
  v_lshlrev_b32 v90, 16, v61
  v_and_b32 v91, 0xffff0000, v61
  v_lshlrev_b32 v92, 16, v62
  v_and_b32 v93, 0xffff0000, v62
  v_lshlrev_b32 v94, 16, v63
  v_and_b32 v95, 0xffff0000, v63
  v_lshlrev_b32 v96, 16, v20
  v_and_b32 v97, 0xffff0000, v20
  v_lshlrev_b32 v98, 16, v21
  v_and_b32 v99, 0xffff0000, v21
  v_lshlrev_b32 v100, 16, v22
  v_and_b32 v101, 0xffff0000, v22
  v_lshlrev_b32 v102, 16, v23
  v_and_b32 v103, 0xffff0000, v23
  v_lshlrev_b32 v104, 16, v24
  v_and_b32 v105, 0xffff0000, v24
  v_lshlrev_b32 v106, 16, v25
  v_and_b32 v107, 0xffff0000, v25
  v_lshlrev_b32 v108, 16, v26
  v_and_b32 v109, 0xffff0000, v26
  v_lshlrev_b32 v110, 16, v27
  v_and_b32 v111, 0xffff0000, v27
  v_lshlrev_b32 v112, 16, v28
  v_and_b32 v113, 0xffff0000, v28
  v_lshlrev_b32 v114, 16, v29
  v_and_b32 v115, 0xffff0000, v29
  v_lshlrev_b32 v116, 16, v30
  v_and_b32 v117, 0xffff0000, v30
  v_lshlrev_b32 v118, 16, v31
  v_and_b32 v119, 0xffff0000, v31
  v_lshlrev_b32 v120, 16, v32
  v_and_b32 v121, 0xffff0000, v32
  v_lshlrev_b32 v122, 16, v33
  v_and_b32 v123, 0xffff0000, v33
  v_lshlrev_b32 v124, 16, v34
  v_and_b32 v125, 0xffff0000, v34
  v_lshlrev_b32 v126, 16, v35
  v_and_b32 v127, 0xffff0000, v35
  v_lshlrev_b32 v128, 16, v36
  v_and_b32 v129, 0xffff0000, v36
  v_lshlrev_b32 v130, 16, v37
  v_and_b32 v131, 0xffff0000, v37
  v_lshlrev_b32 v132, 16, v38
  v_and_b32 v133, 0xffff0000, v38
  v_lshlrev_b32 v134, 16, v39
  v_and_b32 v135, 0xffff0000, v39
  v_lshlrev_b32 v136, 16, v40
  v_and_b32 v137, 0xffff0000, v40
  v_lshlrev_b32 v138, 16, v41
  v_and_b32 v139, 0xffff0000, v41
  v_lshlrev_b32 v140, 16, v42
  v_and_b32 v141, 0xffff0000, v42
  v_lshlrev_b32 v142, 16, v43
  v_and_b32 v143, 0xffff0000, v43
  v_lshlrev_b32 v144, 16, v44
  v_and_b32 v145, 0xffff0000, v44
  v_lshlrev_b32 v146, 16, v45
  v_and_b32 v147, 0xffff0000, v45
  v_lshlrev_b32 v148, 16, v46
  v_and_b32 v149, 0xffff0000, v46
  v_lshlrev_b32 v150, 16, v47
  v_and_b32 v151, 0xffff0000, v47
  v_mul_f32 v20, v96, v67
  v_mul_f32 v21, v97, v71
  v_mul_f32 v22, v104, v66
  v_mul_f32 v23, v105, v70
  v_mul_f32 v24, v112, v65
  v_mul_f32 v25, v113, v69
  v_mul_f32 v26, v120, v64
  v_mul_f32 v27, v121, v68
  v_cvt_pk_bf16_f32 v28, v20, v21
  v_cvt_pk_bf16_f32 v29, v22, v23
  v_cvt_pk_bf16_f32 v30, v24, v25
  v_cvt_pk_bf16_f32 v31, v26, v27
  v_lshlrev_b32 v20, 16, v28
  v_and_b32 v21, 0xffff0000, v28
  v_lshlrev_b32 v22, 16, v29
  v_and_b32 v23, 0xffff0000, v29
  v_lshlrev_b32 v24, 16, v30
  v_and_b32 v25, 0xffff0000, v30
  v_lshlrev_b32 v26, 16, v31
  v_and_b32 v27, 0xffff0000, v31
  v_add_f32 v20, v20, v22
  v_add_f32 v21, v21, v23
  v_cvt_pk_bf16_f32 v32, v20, v21
  v_lshlrev_b32 v20, 16, v32
  v_and_b32 v21, 0xffff0000, v32
  v_add_f32 v20, v20, v24
  v_add_f32 v21, v21, v25
  v_cvt_pk_bf16_f32 v32, v20, v21
  v_lshlrev_b32 v20, 16, v32
  v_and_b32 v21, 0xffff0000, v32
  v_add_f32 v20, v20, v26
  v_add_f32 v21, v21, v27
  v_cvt_pk_bf16_f32 v32, v20, v21
  v_lshlrev_b32 v20, 16, v32
  v_and_b32 v21, 0xffff0000, v32
  v_mul_f32 v136, v20, v136
  v_mul_f32 v137, v21, v137
  v_mul_f32 v20, v98, v75
  v_mul_f32 v21, v99, v79
  v_mul_f32 v22, v106, v74
  v_mul_f32 v23, v107, v78
  v_mul_f32 v24, v114, v73
  v_mul_f32 v25, v115, v77
  v_mul_f32 v26, v122, v72
  v_mul_f32 v27, v123, v76
  v_cvt_pk_bf16_f32 v28, v20, v21
  v_cvt_pk_bf16_f32 v29, v22, v23
  v_cvt_pk_bf16_f32 v30, v24, v25
  v_cvt_pk_bf16_f32 v31, v26, v27
  v_lshlrev_b32 v20, 16, v28
  v_and_b32 v21, 0xffff0000, v28
  v_lshlrev_b32 v22, 16, v29
  v_and_b32 v23, 0xffff0000, v29
  v_lshlrev_b32 v24, 16, v30
  v_and_b32 v25, 0xffff0000, v30
  v_lshlrev_b32 v26, 16, v31
  v_and_b32 v27, 0xffff0000, v31
  v_add_f32 v20, v20, v22
  v_add_f32 v21, v21, v23
  v_cvt_pk_bf16_f32 v32, v20, v21
  v_lshlrev_b32 v20, 16, v32
  v_and_b32 v21, 0xffff0000, v32
  v_add_f32 v20, v20, v24
  v_add_f32 v21, v21, v25
  v_cvt_pk_bf16_f32 v32, v20, v21
  v_lshlrev_b32 v20, 16, v32
  v_and_b32 v21, 0xffff0000, v32
  v_add_f32 v20, v20, v26
  v_add_f32 v21, v21, v27
  v_cvt_pk_bf16_f32 v32, v20, v21
  v_lshlrev_b32 v20, 16, v32
  v_and_b32 v21, 0xffff0000, v32
  v_mul_f32 v138, v20, v138
  v_mul_f32 v139, v21, v139
  v_mul_f32 v20, v100, v83
  v_mul_f32 v21, v101, v87
  v_mul_f32 v22, v108, v82
  v_mul_f32 v23, v109, v86
  v_mul_f32 v24, v116, v81
  v_mul_f32 v25, v117, v85
  v_mul_f32 v26, v124, v80
  v_mul_f32 v27, v125, v84
  v_cvt_pk_bf16_f32 v28, v20, v21
  v_cvt_pk_bf16_f32 v29, v22, v23
  v_cvt_pk_bf16_f32 v30, v24, v25
  v_cvt_pk_bf16_f32 v31, v26, v27
  v_lshlrev_b32 v20, 16, v28
  v_and_b32 v21, 0xffff0000, v28
  v_lshlrev_b32 v22, 16, v29
  v_and_b32 v23, 0xffff0000, v29
  v_lshlrev_b32 v24, 16, v30
  v_and_b32 v25, 0xffff0000, v30
  v_lshlrev_b32 v26, 16, v31
  v_and_b32 v27, 0xffff0000, v31
  v_add_f32 v20, v20, v22
  v_add_f32 v21, v21, v23
  v_cvt_pk_bf16_f32 v32, v20, v21
  v_lshlrev_b32 v20, 16, v32
  v_and_b32 v21, 0xffff0000, v32
  v_add_f32 v20, v20, v24
  v_add_f32 v21, v21, v25
  v_cvt_pk_bf16_f32 v32, v20, v21
  v_lshlrev_b32 v20, 16, v32
  v_and_b32 v21, 0xffff0000, v32
  v_add_f32 v20, v20, v26
  v_add_f32 v21, v21, v27
  v_cvt_pk_bf16_f32 v32, v20, v21
  v_lshlrev_b32 v20, 16, v32
  v_and_b32 v21, 0xffff0000, v32
  v_mul_f32 v140, v20, v140
  v_mul_f32 v141, v21, v141
  v_mul_f32 v20, v102, v91
  v_mul_f32 v21, v103, v95
  v_mul_f32 v22, v110, v90
  v_mul_f32 v23, v111, v94
  v_mul_f32 v24, v118, v89
  v_mul_f32 v25, v119, v93
  v_mul_f32 v26, v126, v88
  v_mul_f32 v27, v127, v92
  v_cvt_pk_bf16_f32 v28, v20, v21
  v_cvt_pk_bf16_f32 v29, v22, v23
  v_cvt_pk_bf16_f32 v30, v24, v25
  v_cvt_pk_bf16_f32 v31, v26, v27
  v_lshlrev_b32 v20, 16, v28
  v_and_b32 v21, 0xffff0000, v28
  v_lshlrev_b32 v22, 16, v29
  v_and_b32 v23, 0xffff0000, v29
  v_lshlrev_b32 v24, 16, v30
  v_and_b32 v25, 0xffff0000, v30
  v_lshlrev_b32 v26, 16, v31
  v_and_b32 v27, 0xffff0000, v31
  v_add_f32 v20, v20, v22
  v_add_f32 v21, v21, v23
  v_cvt_pk_bf16_f32 v32, v20, v21
  v_lshlrev_b32 v20, 16, v32
  v_and_b32 v21, 0xffff0000, v32
  v_add_f32 v20, v20, v24
  v_add_f32 v21, v21, v25
  v_cvt_pk_bf16_f32 v32, v20, v21
  v_lshlrev_b32 v20, 16, v32
  v_and_b32 v21, 0xffff0000, v32
  v_add_f32 v20, v20, v26
  v_add_f32 v21, v21, v27
  v_cvt_pk_bf16_f32 v32, v20, v21
  v_lshlrev_b32 v20, 16, v32
  v_and_b32 v21, 0xffff0000, v32
  v_mul_f32 v142, v20, v142
  v_mul_f32 v143, v21, v143
  v_mul_f32 v20, v104, v67
  v_mul_f32 v21, v105, v71
  v_mul_f32 v22, v112, v66
  v_mul_f32 v23, v113, v70
  v_mul_f32 v24, v120, v65
  v_mul_f32 v25, v121, v69
  v_mul_f32 v26, v128, v64
  v_mul_f32 v27, v129, v68
  v_cvt_pk_bf16_f32 v28, v20, v21
  v_cvt_pk_bf16_f32 v29, v22, v23
  v_cvt_pk_bf16_f32 v30, v24, v25
  v_cvt_pk_bf16_f32 v31, v26, v27
  v_lshlrev_b32 v20, 16, v28
  v_and_b32 v21, 0xffff0000, v28
  v_lshlrev_b32 v22, 16, v29
  v_and_b32 v23, 0xffff0000, v29
  v_lshlrev_b32 v24, 16, v30
  v_and_b32 v25, 0xffff0000, v30
  v_lshlrev_b32 v26, 16, v31
  v_and_b32 v27, 0xffff0000, v31
  v_add_f32 v20, v20, v22
  v_add_f32 v21, v21, v23
  v_cvt_pk_bf16_f32 v32, v20, v21
  v_lshlrev_b32 v20, 16, v32
  v_and_b32 v21, 0xffff0000, v32
  v_add_f32 v20, v20, v24
  v_add_f32 v21, v21, v25
  v_cvt_pk_bf16_f32 v32, v20, v21
  v_lshlrev_b32 v20, 16, v32
  v_and_b32 v21, 0xffff0000, v32
  v_add_f32 v20, v20, v26
  v_add_f32 v21, v21, v27
  v_cvt_pk_bf16_f32 v32, v20, v21
  v_lshlrev_b32 v20, 16, v32
  v_and_b32 v21, 0xffff0000, v32
  v_mul_f32 v144, v20, v144
  v_mul_f32 v145, v21, v145
  v_mul_f32 v20, v106, v75
  v_mul_f32 v21, v107, v79
  v_mul_f32 v22, v114, v74
  v_mul_f32 v23, v115, v78
  v_mul_f32 v24, v122, v73
  v_mul_f32 v25, v123, v77
  v_mul_f32 v26, v130, v72
  v_mul_f32 v27, v131, v76
  v_cvt_pk_bf16_f32 v28, v20, v21
  v_cvt_pk_bf16_f32 v29, v22, v23
  v_cvt_pk_bf16_f32 v30, v24, v25
  v_cvt_pk_bf16_f32 v31, v26, v27
  v_lshlrev_b32 v20, 16, v28
  v_and_b32 v21, 0xffff0000, v28
  v_lshlrev_b32 v22, 16, v29
  v_and_b32 v23, 0xffff0000, v29
  v_lshlrev_b32 v24, 16, v30
  v_and_b32 v25, 0xffff0000, v30
  v_lshlrev_b32 v26, 16, v31
  v_and_b32 v27, 0xffff0000, v31
  v_add_f32 v20, v20, v22
  v_add_f32 v21, v21, v23
  v_cvt_pk_bf16_f32 v32, v20, v21
  v_lshlrev_b32 v20, 16, v32
  v_and_b32 v21, 0xffff0000, v32
  v_add_f32 v20, v20, v24
  v_add_f32 v21, v21, v25
  v_cvt_pk_bf16_f32 v32, v20, v21
  v_lshlrev_b32 v20, 16, v32
  v_and_b32 v21, 0xffff0000, v32
  v_add_f32 v20, v20, v26
  v_add_f32 v21, v21, v27
  v_cvt_pk_bf16_f32 v32, v20, v21
  v_lshlrev_b32 v20, 16, v32
  v_and_b32 v21, 0xffff0000, v32
  v_mul_f32 v146, v20, v146
  v_mul_f32 v147, v21, v147
  v_mul_f32 v20, v108, v83
  v_mul_f32 v21, v109, v87
  v_mul_f32 v22, v116, v82
  v_mul_f32 v23, v117, v86
  v_mul_f32 v24, v124, v81
  v_mul_f32 v25, v125, v85
  v_mul_f32 v26, v132, v80
  v_mul_f32 v27, v133, v84
  v_cvt_pk_bf16_f32 v28, v20, v21
  v_cvt_pk_bf16_f32 v29, v22, v23
  v_cvt_pk_bf16_f32 v30, v24, v25
  v_cvt_pk_bf16_f32 v31, v26, v27
  v_lshlrev_b32 v20, 16, v28
  v_and_b32 v21, 0xffff0000, v28
  v_lshlrev_b32 v22, 16, v29
  v_and_b32 v23, 0xffff0000, v29
  v_lshlrev_b32 v24, 16, v30
  v_and_b32 v25, 0xffff0000, v30
  v_lshlrev_b32 v26, 16, v31
  v_and_b32 v27, 0xffff0000, v31
  v_add_f32 v20, v20, v22
  v_add_f32 v21, v21, v23
  v_cvt_pk_bf16_f32 v32, v20, v21
  v_lshlrev_b32 v20, 16, v32
  v_and_b32 v21, 0xffff0000, v32
  v_add_f32 v20, v20, v24
  v_add_f32 v21, v21, v25
  v_cvt_pk_bf16_f32 v32, v20, v21
  v_lshlrev_b32 v20, 16, v32
  v_and_b32 v21, 0xffff0000, v32
  v_add_f32 v20, v20, v26
  v_add_f32 v21, v21, v27
  v_cvt_pk_bf16_f32 v32, v20, v21
  v_lshlrev_b32 v20, 16, v32
  v_and_b32 v21, 0xffff0000, v32
  v_mul_f32 v148, v20, v148
  v_mul_f32 v149, v21, v149
  v_mul_f32 v20, v110, v91
  v_mul_f32 v21, v111, v95
  v_mul_f32 v22, v118, v90
  v_mul_f32 v23, v119, v94
  v_mul_f32 v24, v126, v89
  v_mul_f32 v25, v127, v93
  v_mul_f32 v26, v134, v88
  v_mul_f32 v27, v135, v92
  v_cvt_pk_bf16_f32 v28, v20, v21
  v_cvt_pk_bf16_f32 v29, v22, v23
  v_cvt_pk_bf16_f32 v30, v24, v25
  v_cvt_pk_bf16_f32 v31, v26, v27
  v_lshlrev_b32 v20, 16, v28
  v_and_b32 v21, 0xffff0000, v28
  v_lshlrev_b32 v22, 16, v29
  v_and_b32 v23, 0xffff0000, v29
  v_lshlrev_b32 v24, 16, v30
  v_and_b32 v25, 0xffff0000, v30
  v_lshlrev_b32 v26, 16, v31
  v_and_b32 v27, 0xffff0000, v31
  v_add_f32 v20, v20, v22
  v_add_f32 v21, v21, v23
  v_cvt_pk_bf16_f32 v32, v20, v21
  v_lshlrev_b32 v20, 16, v32
  v_and_b32 v21, 0xffff0000, v32
  v_add_f32 v20, v20, v24
  v_add_f32 v21, v21, v25
  v_cvt_pk_bf16_f32 v32, v20, v21
  v_lshlrev_b32 v20, 16, v32
  v_and_b32 v21, 0xffff0000, v32
  v_add_f32 v20, v20, v26
  v_add_f32 v21, v21, v27
  v_cvt_pk_bf16_f32 v32, v20, v21
  v_lshlrev_b32 v20, 16, v32
  v_and_b32 v21, 0xffff0000, v32
  v_mul_f32 v150, v20, v150
  v_mul_f32 v151, v21, v151
  v_cvt_pk_bf16_f32 v40, v144, v136
  v_cvt_pk_bf16_f32 v41, v145, v137
  v_cvt_pk_bf16_f32 v42, v146, v138
  v_cvt_pk_bf16_f32 v43, v147, v139
  v_cvt_pk_bf16_f32 v44, v148, v140
  v_cvt_pk_bf16_f32 v45, v149, v141
  v_cvt_pk_bf16_f32 v46, v150, v142
  v_cvt_pk_bf16_f32 v47, v151, v143
  ds_write_b32 v6, v40 offset:0
  ds_write_b32 v6, v41 offset:144
  ds_write_b32 v6, v42 offset:288
  ds_write_b32 v6, v43 offset:432
  ds_write_b32 v6, v44 offset:576
  ds_write_b32 v6, v45 offset:720
  ds_write_b32 v6, v46 offset:864
  ds_write_b32 v6, v47 offset:1008
  s_waitcnt lgkmcnt(0)
  s_barrier
  v_lshrrev_b32 v8, 2, v0
  v_and_b32 v9, 3, v0
  s_movk_i32 s35, 144
  v_mul_lo_u32 v16, v8, s35
  v_lshl_add_u32 v16, v9, 4, v16
  ds_read_b128 v[48:51], v16
  ds_read_b128 v[52:55], v16 offset:64
  s_mul_i32 s36, s30, 278528
  s_lshl_b32 s37, s29, 7
  s_add_u32 s36, s36, s37
  s_movk_i32 s38, 4352
  v_mul_lo_u32 v17, v8, s38
  v_lshl_add_u32 v17, v9, 4, v17
  v_add_u32 v17, s36, v17
  s_waitcnt lgkmcnt(0)
  buffer_store_dwordx4 v[48:51], v17, s[20:23], 0 offen sc1
  buffer_store_dwordx4 v[52:55], v17, s[20:23], 0 offen offset:64 sc1
k0_done:
  s_endpgm
.globl k1_kernel
.p2align 8
.type k1_kernel,@function
k1_kernel:
  s_cmp_ge_u32 s2, 640
  s_cbranch_scc1 k1_done
  s_load_dwordx4 s[4:7], s[0:1], 32
  s_load_dwordx2 s[26:27], s[0:1], 104
  s_load_dwordx4 s[48:51], s[0:1], 64
  s_load_dwordx2 s[52:53], s[0:1], 80
  s_and_b32 s3, s2, 7
  s_mul_i32 s3, s3, 80
  s_lshr_b32 s28, s2, 3
  s_add_u32 s3, s3, s28
  s_lshl_b32 s28, s3, 12
  v_lshlrev_b32 v1, 4, v0
  v_add_u32 v2, -32, v1
  v_add_u32 v3, -16, v1
  s_lshl_b32 s30, s3, 1
  v_mov_b32 v6, s30
  s_waitcnt lgkmcnt(0)
  s_add_u32 s8, s4, s28
  s_addc_u32 s9, s5, 0
  s_movk_i32 s10, 4096
  s_mov_b32 s11, 0x00020000
  s_mul_i32 s29, s3, 4352
  s_add_u32 s29, s29, 0x0
  s_add_u32 s12, s26, s29
  s_addc_u32 s13, s27, 0
  s_movk_i32 s14, 4096
  s_mov_b32 s15, 0x00020000
  s_add_u32 s16, s26, 0x300000
  s_addc_u32 s17, s27, 0
  s_mov_b32 s18, 0x280000
  s_mov_b32 s19, 0x00020000
  s_mov_b32 s20, s6
  s_mov_b32 s21, s7
  s_mov_b32 s22, 0x500
  s_mov_b32 s23, 0x00020000
  buffer_load_dwordx4 v[10:13], v2, s[8:11], 0 offen
  buffer_load_dwordx4 v[14:17], v3, s[8:11], 0 offen
  buffer_load_dwordx4 v[40:43], v1, s[12:15], 0 offen
  buffer_load_dwordx4 v[44:47], v1, s[8:11], 0 offen offset:4064
  buffer_load_dwordx4 v[48:51], v1, s[8:11], 0 offen offset:4080
  buffer_load_ushort v7, v6, s[20:23], 0 offen
  v_mov_b32 v36, 0
  v_mov_b32 v37, 0
  v_mov_b32 v38, 0
  v_mov_b32 v39, 0
  v_cmp_gt_u32 vcc, 32, v0
  s_and_saveexec_b64 s[32:33], vcc
  ds_write_b128 v1, v[36:39] offset:34048
  s_mov_b64 exec, s[32:33]
  s_waitcnt vmcnt(4)
  v_alignbit_b32 v20, v11, v10, 16
  v_alignbit_b32 v21, v12, v11, 16
  v_alignbit_b32 v22, v13, v12, 16
  v_alignbit_b32 v23, v14, v13, 16
  v_alignbit_b32 v24, v15, v14, 16
  v_alignbit_b32 v25, v16, v15, 16
  v_alignbit_b32 v26, v17, v16, 16
  ds_write_b128 v1, v[10:13] offset:0
  ds_write_b128 v1, v[20:23] offset:4256
  v_mov_b32 v32, v11
  v_mov_b32 v33, v12
  v_mov_b32 v34, v13
  v_mov_b32 v35, v14
  ds_write_b128 v1, v[32:35] offset:8512
  v_mov_b32 v32, v21
  v_mov_b32 v33, v22
  v_mov_b32 v34, v23
  v_mov_b32 v35, v24
  ds_write_b128 v1, v[32:35] offset:12768
  ds_write_b128 v1, v[12:15] offset:17024
  ds_write_b128 v1, v[22:25] offset:21280
  v_mov_b32 v32, v13
  v_mov_b32 v33, v14
  v_mov_b32 v34, v15
  v_mov_b32 v35, v16
  ds_write_b128 v1, v[32:35] offset:25536
  v_mov_b32 v32, v23
  v_mov_b32 v33, v24
  v_mov_b32 v34, v25
  v_mov_b32 v35, v26
  ds_write_b128 v1, v[32:35] offset:29792
  s_waitcnt vmcnt(3)
  ds_write_b128 v1, v[40:43] offset:34560
  s_waitcnt vmcnt(1)
  v_cmp_gt_u32 vcc, 2, v0
  s_and_saveexec_b64 s[32:33], vcc
  v_alignbit_b32 v20, v45, v44, 16
  v_alignbit_b32 v21, v46, v45, 16
  v_alignbit_b32 v22, v47, v46, 16
  v_alignbit_b32 v23, v48, v47, 16
  v_alignbit_b32 v24, v49, v48, 16
  v_alignbit_b32 v25, v50, v49, 16
  v_alignbit_b32 v26, v51, v50, 16
  ds_write_b128 v1, v[44:47] offset:4096
  ds_write_b128 v1, v[20:23] offset:8352
  v_mov_b32 v32, v45
  v_mov_b32 v33, v46
  v_mov_b32 v34, v47
  v_mov_b32 v35, v48
  ds_write_b128 v1, v[32:35] offset:12608
  v_mov_b32 v32, v21
  v_mov_b32 v33, v22
  v_mov_b32 v34, v23
  v_mov_b32 v35, v24
  ds_write_b128 v1, v[32:35] offset:16864
  ds_write_b128 v1, v[46:49] offset:21120
  ds_write_b128 v1, v[22:25] offset:25376
  v_mov_b32 v32, v47
  v_mov_b32 v33, v48
  v_mov_b32 v34, v49
  v_mov_b32 v35, v50
  ds_write_b128 v1, v[32:35] offset:29632
  v_mov_b32 v32, v23
  v_mov_b32 v33, v24
  v_mov_b32 v34, v25
  v_mov_b32 v35, v26
  ds_write_b128 v1, v[32:35] offset:33888
  s_mov_b64 exec, s[32:33]
  v_and_b32 v50, 63, v0
  v_lshrrev_b32 v51, 6, v0
  v_and_b32 v52, 15, v50
  v_lshrrev_b32 v53, 4, v50
  v_add_u32 v54, 1, v52
  v_and_b32 v55, 7, v54
  s_movk_i32 s34, 4256
  v_mul_lo_u32 v55, v55, s34
  v_lshrrev_b32 v54, 3, v54
  v_sub_u32 v54, v54, v53
  v_add_u32 v54, 3, v54
  v_lshl_add_u32 v55, v54, 4, v55
  v_lshl_add_u32 v55, v51, 7, v55
  v_lshlrev_b32 v56, 5, v52
  v_lshl_add_u32 v56, v53, 4, v56
  v_add_u32 v56, 34528, v56
  v_lshlrev_b32 v57, 7, v51
  v_sub_u32 v56, v56, v57
  s_waitcnt vmcnt(0) lgkmcnt(0)
  v_and_b32 v26, 63, v0
  v_lshrrev_b32 v27, 6, v0
  v_and_b32 v28, 15, v26
  v_lshrrev_b32 v29, 4, v26
  v_readfirstlane_b32 s54, v27
  v_lshlrev_b32 v30, 4, v26
  s_lshl_b32 s55, s2, 2
  s_add_u32 s55, s55, s54
  s_cmp_ge_u32 s55, 1080
  s_cbranch_scc1 k1_rpd
  s_mov_b32 s56, 0x97B425F
  s_mul_hi_u32 s57, s55, s56
  s_mul_i32 s58, s57, 27
  s_sub_u32 s59, s55, s58
  s_cmp_ge_u32 s57, 20
  s_cselect_b32 s68, s50, s48
  s_cselect_b32 s69, s51, s49
  s_mov_b32 s56, 0x1000000
  s_cselect_b32 s56, 0x1300000, s56
  s_cselect_b32 s58, 20, 0
  s_sub_u32 s57, s57, s58
  s_mov_b32 s70, 0x21c000
  s_mov_b32 s71, 0x00020000
  s_add_u32 s76, s26, s56
  s_addc_u32 s77, s27, 0
  s_mov_b32 s78, 0x21c000
  s_mov_b32 s79, 0x00020000
  s_lshl_b32 s58, s57, 5
  v_lshlrev_b32 v31, 3, v29
  v_add_u32 v31, s58, v31
  s_movk_i32 s58, 3456
  v_mul_lo_u32 v31, v31, s58
  v_lshl_add_u32 v31, v28, 3, v31
  s_lshl_b32 s60, s59, 7
  s_add_u32 s61, s60, 0
  buffer_load_dwordx2 v[10:11], v31, s[68:71], s61 offen
  s_add_u32 s61, s60, 3456
  buffer_load_dwordx2 v[12:13], v31, s[68:71], s61 offen
  s_add_u32 s61, s60, 6912
  buffer_load_dwordx2 v[14:15], v31, s[68:71], s61 offen
  s_add_u32 s61, s60, 10368
  buffer_load_dwordx2 v[16:17], v31, s[68:71], s61 offen
  s_add_u32 s61, s60, 13824
  buffer_load_dwordx2 v[18:19], v31, s[68:71], s61 offen
  s_add_u32 s61, s60, 17280
  buffer_load_dwordx2 v[20:21], v31, s[68:71], s61 offen
  s_add_u32 s61, s60, 20736
  buffer_load_dwordx2 v[22:23], v31, s[68:71], s61 offen
  s_add_u32 s61, s60, 24192
  buffer_load_dwordx2 v[24:25], v31, s[68:71], s61 offen
  s_mul_i32 s72, s59, 81920
  s_lshl_b32 s58, s57, 11
  s_add_u32 s72, s72, s58
  s_add_u32 s73, s72, 1024
  s_add_u32 s74, s72, 40960
  s_add_u32 s75, s72, 41984
  s_branch k1_rpfin
k1_rpd:
  s_sub_u32 s55, s55, 1080
  s_mov_b32 s56, 0x1999999A
  s_mul_hi_u32 s57, s55, s56
  s_mul_i32 s58, s57, 10
  s_sub_u32 s59, s55, s58
  s_mov_b32 s68, s52
  s_mov_b32 s69, s53
  s_cmp_lt_u32 s55, 540
  s_cselect_b32 s70, 0x21c000, 0
  s_mov_b32 s71, 0x00020000
  s_add_u32 s76, s26, 0x1600000
  s_addc_u32 s77, s27, 0
  s_cmp_lt_u32 s55, 540
  s_cselect_b32 s78, 0x21c000, 0
  s_mov_b32 s79, 0x00020000
  s_lshr_b32 s58, s57, 1
  s_lshl_b32 s58, s58, 6
  s_and_b32 s60, s57, 1
  s_lshl_b32 s60, s60, 1
  s_add_u32 s58, s58, s60
  v_lshlrev_b32 v31, 4, v29
  v_add_u32 v31, s58, v31
  s_movk_i32 s58, 1280
  v_mul_lo_u32 v31, v31, s58
  v_lshl_add_u32 v31, v28, 3, v31
  s_lshl_b32 s60, s59, 7
  s_add_u32 s61, s60, 0
  buffer_load_dwordx2 v[10:11], v31, s[68:71], s61 offen
  s_add_u32 s61, s60, 1280
  buffer_load_dwordx2 v[12:13], v31, s[68:71], s61 offen
  s_add_u32 s61, s60, 5120
  buffer_load_dwordx2 v[14:15], v31, s[68:71], s61 offen
  s_add_u32 s61, s60, 6400
  buffer_load_dwordx2 v[16:17], v31, s[68:71], s61 offen
  s_add_u32 s61, s60, 10240
  buffer_load_dwordx2 v[18:19], v31, s[68:71], s61 offen
  s_add_u32 s61, s60, 11520
  buffer_load_dwordx2 v[20:21], v31, s[68:71], s61 offen
  s_add_u32 s61, s60, 15360
  buffer_load_dwordx2 v[22:23], v31, s[68:71], s61 offen
  s_add_u32 s61, s60, 16640
  buffer_load_dwordx2 v[24:25], v31, s[68:71], s61 offen
  s_mul_i32 s72, s59, 221184
  s_lshl_b32 s58, s57, 10
  s_add_u32 s72, s72, s58
  s_add_u32 s73, s72, 55296
  s_add_u32 s74, s72, 110592
  s_add_u32 s75, s72, 165888
k1_rpfin:
  v_mov_b32 v64, 0
  v_mov_b32 v65, 0
  v_mov_b32 v66, 0
  v_mov_b32 v67, 0
  v_mov_b32 v68, 0
  v_mov_b32 v69, 0
  v_mov_b32 v70, 0
  v_mov_b32 v71, 0
  v_mov_b32 v72, 0
  v_mov_b32 v73, 0
  v_mov_b32 v74, 0
  v_mov_b32 v75, 0
  v_mov_b32 v76, 0
  v_mov_b32 v77, 0
  v_mov_b32 v78, 0
  v_mov_b32 v79, 0
  v_mov_b32 v80, 0
  v_mov_b32 v81, 0
  v_mov_b32 v82, 0
  v_mov_b32 v83, 0
  v_mov_b32 v84, 0
  v_mov_b32 v85, 0
  v_mov_b32 v86, 0
  v_mov_b32 v87, 0
  v_mov_b32 v88, 0
  v_mov_b32 v89, 0
  v_mov_b32 v90, 0
  v_mov_b32 v91, 0
  v_mov_b32 v92, 0
  v_mov_b32 v93, 0
  v_mov_b32 v94, 0
  v_mov_b32 v95, 0
  s_mov_b32 s44, 2
  s_barrier
k1_loop:
  ds_read_b128 v[100:103], v56 offset:0
  ds_read_b128 v[104:107], v56 offset:512
  ds_read_b128 v[108:111], v56 offset:1024
  ds_read_b128 v[112:115], v56 offset:1536
  ds_read_b128 v[116:119], v56 offset:2048
  ds_read_b128 v[120:123], v56 offset:2560
  ds_read_b128 v[124:127], v56 offset:3072
  ds_read_b128 v[128:131], v56 offset:3584
  ds_read_b128 v[132:135], v55 offset:0
  ds_read_b128 v[136:139], v55 offset:512
  ds_read_b128 v[140:143], v55 offset:1024
  ds_read_b128 v[144:147], v55 offset:1536
  ds_read_b128 v[148:151], v55 offset:2048
  ds_read_b128 v[152:155], v55 offset:2560
  ds_read_b128 v[156:159], v55 offset:3072
  ds_read_b128 v[160:163], v55 offset:3584
  v_add_u32 v55, 64, v55
  v_add_u32 v56, -64, v56
  s_waitcnt lgkmcnt(7)
  v_mfma_f32_16x16x32_bf16 v[64:67], v[132:135], v[100:103], v[64:67]
  v_mfma_f32_16x16x32_bf16 v[68:71], v[132:135], v[104:107], v[68:71]
  v_mfma_f32_16x16x32_bf16 v[72:75], v[132:135], v[108:111], v[72:75]
  v_mfma_f32_16x16x32_bf16 v[76:79], v[132:135], v[112:115], v[76:79]
  v_mfma_f32_16x16x32_bf16 v[80:83], v[132:135], v[116:119], v[80:83]
  v_mfma_f32_16x16x32_bf16 v[84:87], v[132:135], v[120:123], v[84:87]
  v_mfma_f32_16x16x32_bf16 v[88:91], v[132:135], v[124:127], v[88:91]
  v_mfma_f32_16x16x32_bf16 v[92:95], v[132:135], v[128:131], v[92:95]
  s_waitcnt lgkmcnt(6)
  v_mfma_f32_16x16x32_bf16 v[68:71], v[136:139], v[100:103], v[68:71]
  v_mfma_f32_16x16x32_bf16 v[72:75], v[136:139], v[104:107], v[72:75]
  v_mfma_f32_16x16x32_bf16 v[76:79], v[136:139], v[108:111], v[76:79]
  v_mfma_f32_16x16x32_bf16 v[80:83], v[136:139], v[112:115], v[80:83]
  v_mfma_f32_16x16x32_bf16 v[84:87], v[136:139], v[116:119], v[84:87]
  v_mfma_f32_16x16x32_bf16 v[88:91], v[136:139], v[120:123], v[88:91]
  v_mfma_f32_16x16x32_bf16 v[92:95], v[136:139], v[124:127], v[92:95]
  s_waitcnt lgkmcnt(5)
  v_mfma_f32_16x16x32_bf16 v[72:75], v[140:143], v[100:103], v[72:75]
  v_mfma_f32_16x16x32_bf16 v[76:79], v[140:143], v[104:107], v[76:79]
  v_mfma_f32_16x16x32_bf16 v[80:83], v[140:143], v[108:111], v[80:83]
  v_mfma_f32_16x16x32_bf16 v[84:87], v[140:143], v[112:115], v[84:87]
  v_mfma_f32_16x16x32_bf16 v[88:91], v[140:143], v[116:119], v[88:91]
  v_mfma_f32_16x16x32_bf16 v[92:95], v[140:143], v[120:123], v[92:95]
  s_waitcnt lgkmcnt(4)
  v_mfma_f32_16x16x32_bf16 v[76:79], v[144:147], v[100:103], v[76:79]
  v_mfma_f32_16x16x32_bf16 v[80:83], v[144:147], v[104:107], v[80:83]
  v_mfma_f32_16x16x32_bf16 v[84:87], v[144:147], v[108:111], v[84:87]
  v_mfma_f32_16x16x32_bf16 v[88:91], v[144:147], v[112:115], v[88:91]
  v_mfma_f32_16x16x32_bf16 v[92:95], v[144:147], v[116:119], v[92:95]
  s_waitcnt lgkmcnt(3)
  v_mfma_f32_16x16x32_bf16 v[80:83], v[148:151], v[100:103], v[80:83]
  v_mfma_f32_16x16x32_bf16 v[84:87], v[148:151], v[104:107], v[84:87]
  v_mfma_f32_16x16x32_bf16 v[88:91], v[148:151], v[108:111], v[88:91]
  v_mfma_f32_16x16x32_bf16 v[92:95], v[148:151], v[112:115], v[92:95]
  s_waitcnt lgkmcnt(2)
  v_mfma_f32_16x16x32_bf16 v[84:87], v[152:155], v[100:103], v[84:87]
  v_mfma_f32_16x16x32_bf16 v[88:91], v[152:155], v[104:107], v[88:91]
  v_mfma_f32_16x16x32_bf16 v[92:95], v[152:155], v[108:111], v[92:95]
  s_waitcnt lgkmcnt(1)
  v_mfma_f32_16x16x32_bf16 v[88:91], v[156:159], v[100:103], v[88:91]
  v_mfma_f32_16x16x32_bf16 v[92:95], v[156:159], v[104:107], v[92:95]
  s_waitcnt lgkmcnt(0)
  v_mfma_f32_16x16x32_bf16 v[92:95], v[160:163], v[100:103], v[92:95]
  s_sub_u32 s44, s44, 1
  s_cmp_lg_u32 s44, 0
  s_cbranch_scc1 k1_loop
  s_nop 7
  s_barrier
  v_lshlrev_b32 v58, 4, v50
  v_lshl_add_u32 v58, v51, 13, v58
  ds_write_b128 v58, v[64:67] offset:0
  ds_write_b128 v58, v[68:71] offset:1024
  ds_write_b128 v58, v[72:75] offset:2048
  ds_write_b128 v58, v[76:79] offset:3072
  ds_write_b128 v58, v[80:83] offset:4096
  ds_write_b128 v58, v[84:87] offset:5120
  ds_write_b128 v58, v[88:91] offset:6144
  ds_write_b128 v58, v[92:95] offset:7168
  v_lshlrev_b32 v58, 4, v50
  v_lshl_add_u32 v58, v51, 11, v58
  v_lshlrev_b32 v59, 1, v52
  v_lshrrev_b32 v60, 1, v53
  v_add_u32 v59, v59, v60
  v_lshl_add_u32 v62, v51, 6, v59
  v_lshlrev_b32 v59, 4, v62
  v_and_b32 v63, 1, v53
  v_sub_u32 v60, 1, v63
  v_lshl_add_u32 v59, v60, 3, v59
  ds_read_b64 v[140:141], v59 offset:34560
  ds_read_b64 v[142:143], v59 offset:35072
  v_lshlrev_b32 v61, 16, v7
  s_movk_i32 s34, 10240
  v_mul_lo_u32 v62, v62, s34
  v_lshl_add_u32 v62, v63, 3, v62
  s_lshl_b32 s35, s3, 4
  v_add_u32 v62, s35, v62
  s_mov_b32 s36, 327680
  s_waitcnt lgkmcnt(0)
  s_barrier
  ds_read_b128 v[100:103], v58 offset:0
  ds_read_b128 v[104:107], v58 offset:8192
  ds_read_b128 v[108:111], v58 offset:16384
  ds_read_b128 v[112:115], v58 offset:24576
  ds_read_b128 v[116:119], v58 offset:1024
  ds_read_b128 v[120:123], v58 offset:9216
  ds_read_b128 v[124:127], v58 offset:17408
  ds_read_b128 v[128:131], v58 offset:25600
  s_waitcnt lgkmcnt(4)
  v_add_f32 v100, v100, v104
  v_add_f32 v108, v108, v112
  v_add_f32 v101, v101, v105
  v_add_f32 v109, v109, v113
  v_add_f32 v102, v102, v106
  v_add_f32 v110, v110, v114
  v_add_f32 v103, v103, v107
  v_add_f32 v111, v111, v115
  v_add_f32 v100, v100, v108
  v_add_f32 v101, v101, v109
  v_add_f32 v102, v102, v110
  v_add_f32 v103, v103, v111
  v_cvt_pk_bf16_f32 v150, v100, v101
  v_cvt_pk_bf16_f32 v151, v102, v103
  v_lshlrev_b32 v100, 16, v150
  v_and_b32 v101, 0xffff0000, v150
  v_lshlrev_b32 v102, 16, v151
  v_and_b32 v103, 0xffff0000, v151
  v_lshlrev_b32 v155, 16, v140
  v_and_b32 v154, 0xffff0000, v140
  v_lshlrev_b32 v153, 16, v141
  v_and_b32 v152, 0xffff0000, v141
  v_mul_f32 v152, v152, v61
  v_mul_f32 v153, v153, v61
  v_mul_f32 v154, v154, v61
  v_mul_f32 v155, v155, v61
  v_cvt_pk_bf16_f32 v150, v152, v153
  v_cvt_pk_bf16_f32 v151, v154, v155
  v_lshlrev_b32 v152, 16, v150
  v_and_b32 v153, 0xffff0000, v150
  v_lshlrev_b32 v154, 16, v151
  v_and_b32 v155, 0xffff0000, v151
  v_add_f32 v100, v100, v152
  v_add_f32 v101, v101, v153
  v_add_f32 v102, v102, v154
  v_add_f32 v103, v103, v155
  v_cvt_pk_bf16_f32 v156, v100, v101
  v_cvt_pk_bf16_f32 v157, v102, v103
  buffer_store_dwordx2 v[156:157], v62, s[16:19], 0 offen
  s_waitcnt lgkmcnt(0)
  v_add_f32 v116, v116, v120
  v_add_f32 v124, v124, v128
  v_add_f32 v117, v117, v121
  v_add_f32 v125, v125, v129
  v_add_f32 v118, v118, v122
  v_add_f32 v126, v126, v130
  v_add_f32 v119, v119, v123
  v_add_f32 v127, v127, v131
  v_add_f32 v116, v116, v124
  v_add_f32 v117, v117, v125
  v_add_f32 v118, v118, v126
  v_add_f32 v119, v119, v127
  v_cvt_pk_bf16_f32 v150, v116, v117
  v_cvt_pk_bf16_f32 v151, v118, v119
  v_lshlrev_b32 v116, 16, v150
  v_and_b32 v117, 0xffff0000, v150
  v_lshlrev_b32 v118, 16, v151
  v_and_b32 v119, 0xffff0000, v151
  v_lshlrev_b32 v155, 16, v142
  v_and_b32 v154, 0xffff0000, v142
  v_lshlrev_b32 v153, 16, v143
  v_and_b32 v152, 0xffff0000, v143
  v_mul_f32 v152, v152, v61
  v_mul_f32 v153, v153, v61
  v_mul_f32 v154, v154, v61
  v_mul_f32 v155, v155, v61
  v_cvt_pk_bf16_f32 v150, v152, v153
  v_cvt_pk_bf16_f32 v151, v154, v155
  v_lshlrev_b32 v152, 16, v150
  v_and_b32 v153, 0xffff0000, v150
  v_lshlrev_b32 v154, 16, v151
  v_and_b32 v155, 0xffff0000, v151
  v_add_f32 v116, v116, v152
  v_add_f32 v117, v117, v153
  v_add_f32 v118, v118, v154
  v_add_f32 v119, v119, v155
  v_cvt_pk_bf16_f32 v158, v116, v117
  v_cvt_pk_bf16_f32 v159, v118, v119
  buffer_store_dwordx2 v[158:159], v62, s[16:19], s36 offen
  s_waitcnt vmcnt(2)
  s_mov_b32 s62, 0x05040100
  s_mov_b32 s63, 0x07060302
  v_perm_b32 v32, v12, v10, s62
  v_perm_b32 v33, v16, v14, s62
  v_perm_b32 v34, v20, v18, s62
  v_perm_b32 v35, v24, v22, s62
  buffer_store_dwordx4 v[32:35], v30, s[76:79], s72 offen sc1
  v_perm_b32 v36, v12, v10, s63
  v_perm_b32 v37, v16, v14, s63
  v_perm_b32 v38, v20, v18, s63
  v_perm_b32 v39, v24, v22, s63
  buffer_store_dwordx4 v[36:39], v30, s[76:79], s73 offen sc1
  v_perm_b32 v40, v13, v11, s62
  v_perm_b32 v41, v17, v15, s62
  v_perm_b32 v42, v21, v19, s62
  v_perm_b32 v43, v25, v23, s62
  buffer_store_dwordx4 v[40:43], v30, s[76:79], s74 offen sc1
  v_perm_b32 v44, v13, v11, s63
  v_perm_b32 v45, v17, v15, s63
  v_perm_b32 v46, v21, v19, s63
  v_perm_b32 v47, v25, v23, s63
  buffer_store_dwordx4 v[44:47], v30, s[76:79], s75 offen sc1
k1_done:
  s_endpgm
.globl k2_kernel
.p2align 8
.type k2_kernel,@function
k2_kernel:
  s_cmp_ge_u32 s2, 512
  s_cbranch_scc1 k2_done
  s_load_dwordx2 s[4:5], s[0:1], 0
  s_load_dwordx2 s[6:7], s[0:1], 56
  s_load_dwordx2 s[24:25], s[0:1], 88
  s_load_dwordx2 s[26:27], s[0:1], 104
  v_lshrrev_b32 v2, 6, v0
  v_and_b32 v3, 63, v0
  s_nop 0
  v_readfirstlane_b32 s46, v2
  s_lshl_b32 s47, s2, 2
  s_add_u32 s46, s46, s47
  s_mul_i32 s47, s46, 1280
  s_lshr_b32 s48, s46, 3
  s_mul_i32 s48, s48, 10240
  s_and_b32 s49, s46, 7
  s_lshl_b32 s49, s49, 1
  s_add_u32 s48, s48, s49
  s_mov_b32 s44, 0x3acccccd
  s_mov_b32 s45, 0x3727c5ac
  v_lshlrev_b32 v1, 2, v3
  v_lshlrev_b32 v4, 5, v3
  s_waitcnt lgkmcnt(0)
  s_mov_b32 s8, s4
  s_mov_b32 s9, s5
  s_mov_b32 s10, 0x280000
  s_mov_b32 s11, 0x00020000
  s_mov_b32 s12, s6
  s_mov_b32 s13, s7
  s_mov_b32 s14, 0x500
  s_mov_b32 s15, 0x00020000
  s_mov_b32 s16, s24
  s_mov_b32 s17, s25
  s_mov_b32 s18, 0x280000
  s_mov_b32 s19, 0x00020000
  s_add_u32 s20, s26, 0x300000
  s_addc_u32 s21, s27, 0
  s_mov_b32 s22, 0x280000
  s_mov_b32 s23, 0x00020000
  s_add_u32 s28, s26, 0x600000
  s_addc_u32 s29, s27, 0
  s_mov_b32 s30, 0x280000
  s_mov_b32 s31, 0x00020000
  s_add_u32 s32, s26, 0x900000
  s_addc_u32 s33, s27, 0
  s_mov_b32 s34, 0x280000
  s_mov_b32 s35, 0x00020000
  s_add_u32 s36, s26, 0xc00000
  s_addc_u32 s37, s27, 0
  s_mov_b32 s38, 0x2000
  s_mov_b32 s39, 0x00020000
  buffer_load_dword v10, v1, s[8:11], s47 offen offset:0
  buffer_load_dword v11, v1, s[8:11], s47 offen offset:256
  buffer_load_dword v12, v1, s[8:11], s47 offen offset:512
  buffer_load_dword v13, v1, s[8:11], s47 offen offset:768
  buffer_load_dword v14, v1, s[8:11], s47 offen offset:1024
  buffer_load_ushort v40, v4, s[20:23], s48 offen offset:0
  buffer_load_ushort v41, v4, s[20:23], s48 offen offset:16
  buffer_load_ushort v42, v4, s[20:23], s48 offen offset:2048
  buffer_load_ushort v43, v4, s[20:23], s48 offen offset:2064
  v_add_u32 v5, 4096, v4
  v_add_u32 v6, 8192, v4
  buffer_load_ushort v44, v5, s[20:23], s48 offen offset:0
  buffer_load_ushort v45, v5, s[20:23], s48 offen offset:16
  buffer_load_ushort v46, v5, s[20:23], s48 offen offset:2048
  buffer_load_ushort v47, v5, s[20:23], s48 offen offset:2064
  buffer_load_ushort v48, v6, s[20:23], s48 offen
  buffer_load_ushort v49, v6, s[20:23], s48 offen offset:16
  buffer_load_dword v15, v1, s[12:15], 0 offen offset:0
  buffer_load_dword v16, v1, s[12:15], 0 offen offset:256
  buffer_load_dword v17, v1, s[12:15], 0 offen offset:512
  buffer_load_dword v18, v1, s[12:15], 0 offen offset:768
  buffer_load_dword v19, v1, s[12:15], 0 offen offset:1024
  s_waitcnt vmcnt(15)
  v_lshlrev_b32 v20, 16, v10
  v_and_b32 v21, 0xffff0000, v10
  v_lshlrev_b32 v22, 16, v11
  v_and_b32 v23, 0xffff0000, v11
  v_lshlrev_b32 v24, 16, v12
  v_and_b32 v25, 0xffff0000, v12
  v_lshlrev_b32 v26, 16, v13
  v_and_b32 v27, 0xffff0000, v13
  v_lshlrev_b32 v28, 16, v14
  v_and_b32 v29, 0xffff0000, v14
  v_add_f32 v60, v20, v21
  v_add_f32 v61, v22, v23
  v_add_f32 v62, v24, v25
  v_add_f32 v63, v26, v27
  v_add_f32 v64, v28, v29
  v_add_f32 v60, v60, v61
  v_add_f32 v62, v62, v63
  v_add_f32 v60, v60, v64
  v_add_f32 v60, v60, v62
  s_nop 1
  v_add_f32_dpp v60, v60, v60 row_shr:1 row_mask:0xf bank_mask:0xf bound_ctrl:0
  s_nop 1
  v_add_f32_dpp v60, v60, v60 row_shr:2 row_mask:0xf bank_mask:0xf bound_ctrl:0
  s_nop 1
  v_add_f32_dpp v60, v60, v60 row_shr:4 row_mask:0xf bank_mask:0xf bound_ctrl:0
  s_nop 1
  v_add_f32_dpp v60, v60, v60 row_shr:8 row_mask:0xf bank_mask:0xf bound_ctrl:0
  s_nop 1
  v_add_f32_dpp v60, v60, v60 row_bcast:15 row_mask:0xa bank_mask:0xf
  s_nop 1
  v_add_f32_dpp v60, v60, v60 row_bcast:31 row_mask:0xc bank_mask:0xf
  s_nop 0
  v_readlane_b32 s50, v60, 63
  s_nop 1
  v_mov_b32 v61, s44
  v_mul_f32 v61, s50, v61
  v_sub_f32 v64, v20, v61
  v_sub_f32 v65, v21, v61
  v_sub_f32 v66, v22, v61
  v_sub_f32 v67, v23, v61
  v_sub_f32 v68, v24, v61
  v_sub_f32 v69, v25, v61
  v_sub_f32 v70, v26, v61
  v_sub_f32 v71, v27, v61
  v_sub_f32 v72, v28, v61
  v_sub_f32 v73, v29, v61
  v_mul_f32 v60, v64, v64
  v_mul_f32 v62, v65, v65
  v_fmac_f32 v60, v66, v66
  v_fmac_f32 v62, v67, v67
  v_fmac_f32 v60, v68, v68
  v_fmac_f32 v62, v69, v69
  v_fmac_f32 v60, v70, v70
  v_fmac_f32 v62, v71, v71
  v_fmac_f32 v60, v72, v72
  v_fmac_f32 v62, v73, v73
  v_add_f32 v60, v60, v62
  s_nop 1
  v_add_f32_dpp v60, v60, v60 row_shr:1 row_mask:0xf bank_mask:0xf bound_ctrl:0
  s_nop 1
  v_add_f32_dpp v60, v60, v60 row_shr:2 row_mask:0xf bank_mask:0xf bound_ctrl:0
  s_nop 1
  v_add_f32_dpp v60, v60, v60 row_shr:4 row_mask:0xf bank_mask:0xf bound_ctrl:0
  s_nop 1
  v_add_f32_dpp v60, v60, v60 row_shr:8 row_mask:0xf bank_mask:0xf bound_ctrl:0
  s_nop 1
  v_add_f32_dpp v60, v60, v60 row_bcast:15 row_mask:0xa bank_mask:0xf
  s_nop 1
  v_add_f32_dpp v60, v60, v60 row_bcast:31 row_mask:0xc bank_mask:0xf
  s_nop 0
  v_readlane_b32 s51, v60, 63
  s_nop 1
  v_mov_b32 v62, s44
  v_mul_f32 v62, s51, v62
  v_cvt_pk_bf16_f32 v63, v61, v62
  v_lshlrev_b32 v61, 16, v63
  v_and_b32 v62, 0xffff0000, v63
  v_add_f32 v62, s45, v62
  v_cvt_pk_bf16_f32 v63, v62, v62
  v_lshlrev_b32 v62, 16, v63
  v_sqrt_f32 v62, v62
  s_nop 0
  v_cvt_pk_bf16_f32 v63, v62, v62
  v_lshlrev_b32 v62, 16, v63
  v_rcp_f32 v62, v62
  v_sub_f32 v64, v20, v61
  v_sub_f32 v65, v21, v61
  v_sub_f32 v66, v22, v61
  v_sub_f32 v67, v23, v61
  v_sub_f32 v68, v24, v61
  v_sub_f32 v69, v25, v61
  v_sub_f32 v70, v26, v61
  v_sub_f32 v71, v27, v61
  v_sub_f32 v72, v28, v61
  v_sub_f32 v73, v29, v61
  v_cvt_pk_bf16_f32 v63, v64, v65
  v_lshlrev_b32 v64, 16, v63
  v_and_b32 v65, 0xffff0000, v63
  v_cvt_pk_bf16_f32 v63, v66, v67
  v_lshlrev_b32 v66, 16, v63
  v_and_b32 v67, 0xffff0000, v63
  v_cvt_pk_bf16_f32 v63, v68, v69
  v_lshlrev_b32 v68, 16, v63
  v_and_b32 v69, 0xffff0000, v63
  v_cvt_pk_bf16_f32 v63, v70, v71
  v_lshlrev_b32 v70, 16, v63
  v_and_b32 v71, 0xffff0000, v63
  v_cvt_pk_bf16_f32 v63, v72, v73
  v_lshlrev_b32 v72, 16, v63
  v_and_b32 v73, 0xffff0000, v63
  v_mul_f32 v30, v64, v62
  v_mul_f32 v31, v65, v62
  v_mul_f32 v32, v66, v62
  v_mul_f32 v33, v67, v62
  v_mul_f32 v34, v68, v62
  v_mul_f32 v35, v69, v62
  v_mul_f32 v36, v70, v62
  v_mul_f32 v37, v71, v62
  v_mul_f32 v38, v72, v62
  v_mul_f32 v39, v73, v62
  v_cvt_pk_bf16_f32 v63, v30, v31
  v_lshlrev_b32 v30, 16, v63
  v_and_b32 v31, 0xffff0000, v63
  v_cvt_pk_bf16_f32 v63, v32, v33
  v_lshlrev_b32 v32, 16, v63
  v_and_b32 v33, 0xffff0000, v63
  v_cvt_pk_bf16_f32 v63, v34, v35
  v_lshlrev_b32 v34, 16, v63
  v_and_b32 v35, 0xffff0000, v63
  v_cvt_pk_bf16_f32 v63, v36, v37
  v_lshlrev_b32 v36, 16, v63
  v_and_b32 v37, 0xffff0000, v63
  v_cvt_pk_bf16_f32 v63, v38, v39
  v_lshlrev_b32 v38, 16, v63
  v_and_b32 v39, 0xffff0000, v63
  s_waitcnt vmcnt(5)
  v_lshlrev_b32 v40, 16, v40
  v_lshlrev_b32 v41, 16, v41
  v_lshlrev_b32 v42, 16, v42
  v_lshlrev_b32 v43, 16, v43
  v_lshlrev_b32 v44, 16, v44
  v_lshlrev_b32 v45, 16, v45
  v_lshlrev_b32 v46, 16, v46
  v_lshlrev_b32 v47, 16, v47
  v_lshlrev_b32 v48, 16, v48
  v_lshlrev_b32 v49, 16, v49
  v_mul_f32 v40, v30, v40
  v_mul_f32 v41, v31, v41
  v_mul_f32 v42, v32, v42
  v_mul_f32 v43, v33, v43
  v_mul_f32 v44, v34, v44
  v_mul_f32 v45, v35, v45
  v_mul_f32 v46, v36, v46
  v_mul_f32 v47, v37, v47
  v_mul_f32 v48, v38, v48
  v_mul_f32 v49, v39, v49
  v_cvt_pk_bf16_f32 v63, v40, v41
  v_lshlrev_b32 v40, 16, v63
  v_and_b32 v41, 0xffff0000, v63
  v_cvt_pk_bf16_f32 v63, v42, v43
  v_lshlrev_b32 v42, 16, v63
  v_and_b32 v43, 0xffff0000, v63
  v_cvt_pk_bf16_f32 v63, v44, v45
  v_lshlrev_b32 v44, 16, v63
  v_and_b32 v45, 0xffff0000, v63
  v_cvt_pk_bf16_f32 v63, v46, v47
  v_lshlrev_b32 v46, 16, v63
  v_and_b32 v47, 0xffff0000, v63
  v_cvt_pk_bf16_f32 v63, v48, v49
  v_lshlrev_b32 v48, 16, v63
  v_and_b32 v49, 0xffff0000, v63
  v_add_f32 v40, v20, v40
  v_add_f32 v41, v21, v41
  v_add_f32 v42, v22, v42
  v_add_f32 v43, v23, v43
  v_add_f32 v44, v24, v44
  v_add_f32 v45, v25, v45
  v_add_f32 v46, v26, v46
  v_add_f32 v47, v27, v47
  v_add_f32 v48, v28, v48
  v_add_f32 v49, v29, v49
  v_cvt_pk_bf16_f32 v10, v40, v41
  v_lshlrev_b32 v40, 16, v10
  v_and_b32 v41, 0xffff0000, v10
  v_cvt_pk_bf16_f32 v11, v42, v43
  v_lshlrev_b32 v42, 16, v11
  v_and_b32 v43, 0xffff0000, v11
  v_cvt_pk_bf16_f32 v12, v44, v45
  v_lshlrev_b32 v44, 16, v12
  v_and_b32 v45, 0xffff0000, v12
  v_cvt_pk_bf16_f32 v13, v46, v47
  v_lshlrev_b32 v46, 16, v13
  v_and_b32 v47, 0xffff0000, v13
  v_cvt_pk_bf16_f32 v14, v48, v49
  v_lshlrev_b32 v48, 16, v14
  v_and_b32 v49, 0xffff0000, v14
  buffer_store_dword v10, v1, s[28:31], s47 offen offset:0 sc1
  buffer_store_dword v11, v1, s[28:31], s47 offen offset:256 sc1
  buffer_store_dword v12, v1, s[28:31], s47 offen offset:512 sc1
  buffer_store_dword v13, v1, s[28:31], s47 offen offset:768 sc1
  buffer_store_dword v14, v1, s[28:31], s47 offen offset:1024 sc1
  v_add_f32 v60, v40, v41
  v_add_f32 v61, v42, v43
  v_add_f32 v62, v44, v45
  v_add_f32 v63, v46, v47
  v_add_f32 v64, v48, v49
  v_add_f32 v60, v60, v61
  v_add_f32 v62, v62, v63
  v_add_f32 v60, v60, v64
  v_add_f32 v60, v60, v62
  s_nop 1
  v_add_f32_dpp v60, v60, v60 row_shr:1 row_mask:0xf bank_mask:0xf bound_ctrl:0
  s_nop 1
  v_add_f32_dpp v60, v60, v60 row_shr:2 row_mask:0xf bank_mask:0xf bound_ctrl:0
  s_nop 1
  v_add_f32_dpp v60, v60, v60 row_shr:4 row_mask:0xf bank_mask:0xf bound_ctrl:0
  s_nop 1
  v_add_f32_dpp v60, v60, v60 row_shr:8 row_mask:0xf bank_mask:0xf bound_ctrl:0
  s_nop 1
  v_add_f32_dpp v60, v60, v60 row_bcast:15 row_mask:0xa bank_mask:0xf
  s_nop 1
  v_add_f32_dpp v60, v60, v60 row_bcast:31 row_mask:0xc bank_mask:0xf
  s_nop 0
  v_readlane_b32 s50, v60, 63
  s_nop 1
  v_mov_b32 v61, s44
  v_mul_f32 v61, s50, v61
  v_sub_f32 v64, v40, v61
  v_sub_f32 v65, v41, v61
  v_sub_f32 v66, v42, v61
  v_sub_f32 v67, v43, v61
  v_sub_f32 v68, v44, v61
  v_sub_f32 v69, v45, v61
  v_sub_f32 v70, v46, v61
  v_sub_f32 v71, v47, v61
  v_sub_f32 v72, v48, v61
  v_sub_f32 v73, v49, v61
  v_mul_f32 v60, v64, v64
  v_mul_f32 v62, v65, v65
  v_fmac_f32 v60, v66, v66
  v_fmac_f32 v62, v67, v67
  v_fmac_f32 v60, v68, v68
  v_fmac_f32 v62, v69, v69
  v_fmac_f32 v60, v70, v70
  v_fmac_f32 v62, v71, v71
  v_fmac_f32 v60, v72, v72
  v_fmac_f32 v62, v73, v73
  v_add_f32 v60, v60, v62
  s_nop 1
  v_add_f32_dpp v60, v60, v60 row_shr:1 row_mask:0xf bank_mask:0xf bound_ctrl:0
  s_nop 1
  v_add_f32_dpp v60, v60, v60 row_shr:2 row_mask:0xf bank_mask:0xf bound_ctrl:0
  s_nop 1
  v_add_f32_dpp v60, v60, v60 row_shr:4 row_mask:0xf bank_mask:0xf bound_ctrl:0
  s_nop 1
  v_add_f32_dpp v60, v60, v60 row_shr:8 row_mask:0xf bank_mask:0xf bound_ctrl:0
  s_nop 1
  v_add_f32_dpp v60, v60, v60 row_bcast:15 row_mask:0xa bank_mask:0xf
  s_nop 1
  v_add_f32_dpp v60, v60, v60 row_bcast:31 row_mask:0xc bank_mask:0xf
  s_nop 0
  v_readlane_b32 s51, v60, 63
  s_nop 1
  v_mov_b32 v62, s44
  v_mul_f32 v62, s51, v62
  v_cvt_pk_bf16_f32 v63, v61, v62
  v_lshlrev_b32 v61, 16, v63
  v_and_b32 v62, 0xffff0000, v63
  v_add_f32 v62, s45, v62
  v_cvt_pk_bf16_f32 v63, v62, v62
  v_lshlrev_b32 v62, 16, v63
  v_sqrt_f32 v62, v62
  s_nop 0
  v_cvt_pk_bf16_f32 v63, v62, v62
  v_lshlrev_b32 v62, 16, v63
  v_rcp_f32 v62, v62
  v_sub_f32 v64, v40, v61
  v_sub_f32 v65, v41, v61
  v_sub_f32 v66, v42, v61
  v_sub_f32 v67, v43, v61
  v_sub_f32 v68, v44, v61
  v_sub_f32 v69, v45, v61
  v_sub_f32 v70, v46, v61
  v_sub_f32 v71, v47, v61
  v_sub_f32 v72, v48, v61
  v_sub_f32 v73, v49, v61
  v_cvt_pk_bf16_f32 v63, v64, v65
  v_lshlrev_b32 v64, 16, v63
  v_and_b32 v65, 0xffff0000, v63
  v_cvt_pk_bf16_f32 v63, v66, v67
  v_lshlrev_b32 v66, 16, v63
  v_and_b32 v67, 0xffff0000, v63
  v_cvt_pk_bf16_f32 v63, v68, v69
  v_lshlrev_b32 v68, 16, v63
  v_and_b32 v69, 0xffff0000, v63
  v_cvt_pk_bf16_f32 v63, v70, v71
  v_lshlrev_b32 v70, 16, v63
  v_and_b32 v71, 0xffff0000, v63
  v_cvt_pk_bf16_f32 v63, v72, v73
  v_lshlrev_b32 v72, 16, v63
  v_and_b32 v73, 0xffff0000, v63
  v_mul_f32 v30, v64, v62
  v_mul_f32 v31, v65, v62
  v_mul_f32 v32, v66, v62
  v_mul_f32 v33, v67, v62
  v_mul_f32 v34, v68, v62
  v_mul_f32 v35, v69, v62
  v_mul_f32 v36, v70, v62
  v_mul_f32 v37, v71, v62
  v_mul_f32 v38, v72, v62
  v_mul_f32 v39, v73, v62
  v_cvt_pk_bf16_f32 v63, v30, v31
  v_lshlrev_b32 v30, 16, v63
  v_and_b32 v31, 0xffff0000, v63
  v_cvt_pk_bf16_f32 v63, v32, v33
  v_lshlrev_b32 v32, 16, v63
  v_and_b32 v33, 0xffff0000, v63
  v_cvt_pk_bf16_f32 v63, v34, v35
  v_lshlrev_b32 v34, 16, v63
  v_and_b32 v35, 0xffff0000, v63
  v_cvt_pk_bf16_f32 v63, v36, v37
  v_lshlrev_b32 v36, 16, v63
  v_and_b32 v37, 0xffff0000, v63
  v_cvt_pk_bf16_f32 v63, v38, v39
  v_lshlrev_b32 v38, 16, v63
  v_and_b32 v39, 0xffff0000, v63
  v_cvt_pk_bf16_f32 v80, v30, v31
  v_cvt_pk_bf16_f32 v81, v32, v33
  v_cvt_pk_bf16_f32 v82, v34, v35
  v_cvt_pk_bf16_f32 v83, v36, v37
  v_cvt_pk_bf16_f32 v84, v38, v39
  buffer_store_dword v80, v1, s[32:35], s47 offen offset:0 sc1
  buffer_store_dword v81, v1, s[32:35], s47 offen offset:256 sc1
  buffer_store_dword v82, v1, s[32:35], s47 offen offset:512 sc1
  buffer_store_dword v83, v1, s[32:35], s47 offen offset:768 sc1
  buffer_store_dword v84, v1, s[32:35], s47 offen offset:1024 sc1
  v_add_f32 v20, v40, v30
  v_add_f32 v21, v41, v31
  v_add_f32 v22, v42, v32
  v_add_f32 v23, v43, v33
  v_add_f32 v24, v44, v34
  v_add_f32 v25, v45, v35
  v_add_f32 v26, v46, v36
  v_add_f32 v27, v47, v37
  v_add_f32 v28, v48, v38
  v_add_f32 v29, v49, v39
  v_cvt_pk_bf16_f32 v85, v20, v21
  v_cvt_pk_bf16_f32 v86, v22, v23
  v_cvt_pk_bf16_f32 v87, v24, v25
  v_cvt_pk_bf16_f32 v88, v26, v27
  v_cvt_pk_bf16_f32 v89, v28, v29
  buffer_store_dword v85, v1, s[16:19], s47 offen offset:0 sc1
  buffer_store_dword v86, v1, s[16:19], s47 offen offset:256 sc1
  buffer_store_dword v87, v1, s[16:19], s47 offen offset:512 sc1
  buffer_store_dword v88, v1, s[16:19], s47 offen offset:768 sc1
  buffer_store_dword v89, v1, s[16:19], s47 offen offset:1024 sc1
  s_waitcnt vmcnt(15)
  v_lshlrev_b32 v64, 16, v15
  v_and_b32 v65, 0xffff0000, v15
  v_lshlrev_b32 v66, 16, v16
  v_and_b32 v67, 0xffff0000, v16
  v_lshlrev_b32 v68, 16, v17
  v_and_b32 v69, 0xffff0000, v17
  v_lshlrev_b32 v70, 16, v18
  v_and_b32 v71, 0xffff0000, v18
  v_lshlrev_b32 v72, 16, v19
  v_and_b32 v73, 0xffff0000, v19
  v_mul_f32 v60, v30, v64
  v_mul_f32 v61, v31, v65
  v_fmac_f32 v60, v32, v66
  v_fmac_f32 v61, v33, v67
  v_fmac_f32 v60, v34, v68
  v_fmac_f32 v61, v35, v69
  v_fmac_f32 v60, v36, v70
  v_fmac_f32 v61, v37, v71
  v_fmac_f32 v60, v38, v72
  v_fmac_f32 v61, v39, v73
  v_add_f32 v60, v60, v61
  s_nop 1
  v_add_f32_dpp v60, v60, v60 row_shr:1 row_mask:0xf bank_mask:0xf bound_ctrl:0
  s_nop 1
  v_add_f32_dpp v60, v60, v60 row_shr:2 row_mask:0xf bank_mask:0xf bound_ctrl:0
  s_nop 1
  v_add_f32_dpp v60, v60, v60 row_shr:4 row_mask:0xf bank_mask:0xf bound_ctrl:0
  s_nop 1
  v_add_f32_dpp v60, v60, v60 row_shr:8 row_mask:0xf bank_mask:0xf bound_ctrl:0
  s_nop 1
  v_add_f32_dpp v60, v60, v60 row_bcast:15 row_mask:0xa bank_mask:0xf
  s_nop 1
  v_add_f32_dpp v60, v60, v60 row_bcast:31 row_mask:0xc bank_mask:0xf
  s_nop 0
  v_readlane_b32 s57, v60, 63
  s_nop 1
  v_mov_b32 v60, s57
  v_cvt_pk_bf16_f32 v60, v60, v60
  v_lshlrev_b32 v60, 16, v60
  s_lshl_b32 s49, s46, 2
  v_mov_b32 v7, 0
  v_cmp_eq_u32 vcc, 0, v3
  s_and_saveexec_b64 s[40:41], vcc
  buffer_store_dword v60, v7, s[36:39], s49 offen
k2_done:
  s_endpgm
.globl k3_kernel
.p2align 8
.type k3_kernel,@function
k3_kernel:
  s_cmp_ge_u32 s2, 54
  s_cbranch_scc1 k3_done
  s_load_dwordx4 s[4:7], s[0:1], 64
  s_load_dwordx4 s[24:27], s[0:1], 80
  s_load_dwordx4 s[52:55], s[0:1], 96
  v_and_b32 v1, 255, v0
  v_lshlrev_b32 v1, 5, v1
  v_and_b32 v2, 63, v0
  v_lshrrev_b32 v3, 6, v0
  v_and_b32 v4, 15, v2
  v_lshrrev_b32 v5, 4, v2
  v_readfirstlane_b32 s68, v3
  v_and_b32 v6, 3, v3
  s_movk_i32 s44, 160
  v_mul_lo_u32 v6, v6, s44
  v_lshl_add_u32 v6, v5, 3, v6
  v_lshlrev_b32 v7, 4, v2
  s_and_b32 s45, s68, 3
  s_mul_i32 s45, s45, 10240
  s_mul_i32 s46, s2, 40960
  s_add_u32 s45, s45, s46
  s_mul_i32 s48, s2, 55296
  s_lshl_b32 s49, s68, 10
  s_add_u32 s48, s48, s49
  s_waitcnt lgkmcnt(0)
  s_cmp_ge_u32 s68, 4
  s_mov_b32 s49, 0x1000000
  s_cselect_b32 s49, 0x1300000, s49
  s_add_u32 s8, s54, s49
  s_addc_u32 s9, s55, 0
  s_mov_b32 s10, 0x21c000
  s_mov_b32 s11, 0x00020000
  s_add_u32 s16, s54, 0xc00000
  s_addc_u32 s17, s55, 0
  s_mov_b32 s18, 0x2000
  s_mov_b32 s19, 0x00020000
  s_add_u32 s20, s54, 0x900000
  s_addc_u32 s21, s55, 0
  s_mov_b32 s22, 0x280000
  s_mov_b32 s23, 0x00020000
  s_add_u32 s28, s54, 0x1600000
  s_addc_u32 s29, s55, 0
  s_mov_b32 s30, 0x21c000
  s_mov_b32 s31, 0x00020000
  s_add_u32 s32, s54, 0xc10000
  s_addc_u32 s33, s55, 0
  s_mov_b32 s34, 0x6c00
  s_mov_b32 s35, 0x00020000
  s_add_u32 s56, s54, 0x600000
  s_addc_u32 s57, s55, 0
  s_mov_b32 s58, 0x280000
  s_mov_b32 s59, 0x00020000
  s_mov_b32 s60, s26
  s_mov_b32 s61, s27
  s_mov_b32 s62, 0x280000
  s_mov_b32 s63, 0x00020000
  s_mov_b32 s64, s52
  s_mov_b32 s65, s53
  s_mov_b32 s66, 0x100
  s_mov_b32 s67, 0x00020000
  buffer_load_dwordx4 v[10:13], v1, s[16:19], 0 offen
  buffer_load_dwordx4 v[14:17], v1, s[16:19], 0 offen offset:16
  s_add_u32 s47, s45, 0
  buffer_load_dwordx4 v[96:99], v7, s[8:11], s47 offen
  s_add_u32 s47, s45, 1024
  buffer_load_dwordx4 v[100:103], v7, s[8:11], s47 offen
  s_add_u32 s47, s45, 2048
  buffer_load_dwordx4 v[104:107], v7, s[8:11], s47 offen
  s_add_u32 s47, s45, 3072
  buffer_load_dwordx4 v[108:111], v7, s[8:11], s47 offen
  s_add_u32 s47, s45, 4096
  buffer_load_dwordx4 v[112:115], v7, s[8:11], s47 offen
  s_add_u32 s47, s45, 5120
  buffer_load_dwordx4 v[116:119], v7, s[8:11], s47 offen
  s_add_u32 s47, s45, 6144
  buffer_load_dwordx4 v[120:123], v7, s[8:11], s47 offen
  s_add_u32 s47, s45, 7168
  buffer_load_dwordx4 v[124:127], v7, s[8:11], s47 offen
  s_add_u32 s47, s45, 8192
  buffer_load_dwordx4 v[128:131], v7, s[8:11], s47 offen
  s_add_u32 s47, s45, 9216
  buffer_load_dwordx4 v[132:135], v7, s[8:11], s47 offen
  s_add_u32 s47, s48, 0
  buffer_load_dwordx4 v[136:139], v7, s[28:31], s47 offen
  s_add_u32 s47, s48, 8192
  buffer_load_dwordx4 v[140:143], v7, s[28:31], s47 offen
  s_add_u32 s47, s48, 16384
  buffer_load_dwordx4 v[144:147], v7, s[28:31], s47 offen
  s_add_u32 s47, s48, 24576
  buffer_load_dwordx4 v[148:151], v7, s[28:31], s47 offen
  s_add_u32 s47, s48, 32768
  buffer_load_dwordx4 v[152:155], v7, s[28:31], s47 offen
  s_add_u32 s47, s48, 40960
  buffer_load_dwordx4 v[156:159], v7, s[28:31], s47 offen
  s_add_u32 s47, s48, 49152
  buffer_load_dwordx4 v[160:163], v7, s[28:31], s47 offen
  s_waitcnt vmcnt(17)
  v_ashrrev_i32 v20, 31, v10
  v_or_b32 v20, 0x80000000, v20
  v_xor_b32 v10, v10, v20
  v_and_b32 v10, 0xffff0000, v10
  v_lshlrev_b32 v21, 3, v0
  v_sub_u32 v21, 65535, v21
  v_or_b32 v10, v10, v21
  v_ashrrev_i32 v20, 31, v11
  v_or_b32 v20, 0x80000000, v20
  v_xor_b32 v11, v11, v20
  v_and_b32 v11, 0xffff0000, v11
  v_lshlrev_b32 v21, 3, v0
  v_sub_u32 v21, 65534, v21
  v_or_b32 v11, v11, v21
  v_ashrrev_i32 v20, 31, v12
  v_or_b32 v20, 0x80000000, v20
  v_xor_b32 v12, v12, v20
  v_and_b32 v12, 0xffff0000, v12
  v_lshlrev_b32 v21, 3, v0
  v_sub_u32 v21, 65533, v21
  v_or_b32 v12, v12, v21
  v_ashrrev_i32 v20, 31, v13
  v_or_b32 v20, 0x80000000, v20
  v_xor_b32 v13, v13, v20
  v_and_b32 v13, 0xffff0000, v13
  v_lshlrev_b32 v21, 3, v0
  v_sub_u32 v21, 65532, v21
  v_or_b32 v13, v13, v21
  v_ashrrev_i32 v20, 31, v14
  v_or_b32 v20, 0x80000000, v20
  v_xor_b32 v14, v14, v20
  v_and_b32 v14, 0xffff0000, v14
  v_lshlrev_b32 v21, 3, v0
  v_sub_u32 v21, 65531, v21
  v_or_b32 v14, v14, v21
  v_ashrrev_i32 v20, 31, v15
  v_or_b32 v20, 0x80000000, v20
  v_xor_b32 v15, v15, v20
  v_and_b32 v15, 0xffff0000, v15
  v_lshlrev_b32 v21, 3, v0
  v_sub_u32 v21, 65530, v21
  v_or_b32 v15, v15, v21
  v_ashrrev_i32 v20, 31, v16
  v_or_b32 v20, 0x80000000, v20
  v_xor_b32 v16, v16, v20
  v_and_b32 v16, 0xffff0000, v16
  v_lshlrev_b32 v21, 3, v0
  v_sub_u32 v21, 65529, v21
  v_or_b32 v16, v16, v21
  v_ashrrev_i32 v20, 31, v17
  v_or_b32 v20, 0x80000000, v20
  v_xor_b32 v17, v17, v20
  v_and_b32 v17, 0xffff0000, v17
  v_lshlrev_b32 v21, 3, v0
  v_sub_u32 v21, 65528, v21
  v_or_b32 v17, v17, v21
  v_mov_b32 v30, 0
  s_cmp_ge_u32 s68, 4
  s_cbranch_scc1 k3_tk_skip
  v_max_u32 v20, v10, v11
  v_min_u32 v11, v10, v11
  v_mov_b32 v10, v20
  v_max_u32 v20, v12, v13
  v_min_u32 v13, v12, v13
  v_mov_b32 v12, v20
  v_max_u32 v20, v14, v15
  v_min_u32 v15, v14, v15
  v_mov_b32 v14, v20
  v_max_u32 v20, v16, v17
  v_min_u32 v17, v16, v17
  v_mov_b32 v16, v20
  v_max_u32 v20, v10, v12
  v_min_u32 v12, v10, v12
  v_mov_b32 v10, v20
  v_max_u32 v20, v11, v13
  v_min_u32 v13, v11, v13
  v_mov_b32 v11, v20
  v_max_u32 v20, v14, v16
  v_min_u32 v16, v14, v16
  v_mov_b32 v14, v20
  v_max_u32 v20, v15, v17
  v_min_u32 v17, v15, v17
  v_mov_b32 v15, v20
  v_max_u32 v20, v11, v12
  v_min_u32 v12, v11, v12
  v_mov_b32 v11, v20
  v_max_u32 v20, v15, v16
  v_min_u32 v16, v15, v16
  v_mov_b32 v15, v20
  v_max_u32 v20, v10, v14
  v_min_u32 v14, v10, v14
  v_mov_b32 v10, v20
  v_max_u32 v20, v13, v17
  v_min_u32 v17, v13, v17
  v_mov_b32 v13, v20
  v_max_u32 v20, v11, v15
  v_min_u32 v15, v11, v15
  v_mov_b32 v11, v20
  v_max_u32 v20, v12, v16
  v_min_u32 v16, v12, v16
  v_mov_b32 v12, v20
  v_max_u32 v20, v11, v14
  v_min_u32 v14, v11, v14
  v_mov_b32 v11, v20
  v_max_u32 v20, v13, v16
  v_min_u32 v16, v13, v16
  v_mov_b32 v13, v20
  v_max_u32 v20, v12, v14
  v_min_u32 v14, v12, v14
  v_mov_b32 v12, v20
  v_max_u32 v20, v13, v15
  v_min_u32 v15, v13, v15
  v_mov_b32 v13, v20
  v_max_u32 v20, v13, v14
  v_min_u32 v14, v13, v14
  v_mov_b32 v13, v20
  v_mov_b32 v20, v10
  s_nop 1
  v_max_u32_dpp v20, v20, v20 row_shr:1 row_mask:0xf bank_mask:0xf bound_ctrl:0
  s_nop 1
  v_max_u32_dpp v20, v20, v20 row_shr:2 row_mask:0xf bank_mask:0xf bound_ctrl:0
  s_nop 1
  v_max_u32_dpp v20, v20, v20 row_shr:4 row_mask:0xf bank_mask:0xf bound_ctrl:0
  s_nop 1
  v_max_u32_dpp v20, v20, v20 row_shr:8 row_mask:0xf bank_mask:0xf bound_ctrl:0
  s_nop 1
  v_max_u32_dpp v20, v20, v20 row_bcast:15 row_mask:0xa bank_mask:0xf
  s_nop 1
  v_max_u32_dpp v20, v20, v20 row_bcast:31 row_mask:0xc bank_mask:0xf
  s_nop 0
  v_readlane_b32 s50, v20, 63
  s_nop 1
  v_cmp_eq_u32 vcc, s50, v10
  v_writelane_b32 v30, s50, 0
  s_nop 0
  v_cndmask_b32 v10, v10, v11, vcc
  v_cndmask_b32 v11, v11, v12, vcc
  v_cndmask_b32 v12, v12, v13, vcc
  v_cndmask_b32 v13, v13, v14, vcc
  v_cndmask_b32 v14, v14, v15, vcc
  v_cndmask_b32 v15, v15, v16, vcc
  v_cndmask_b32 v16, v16, v17, vcc
  v_cndmask_b32 v17, v17, 0, vcc
  v_mov_b32 v20, v10
  s_nop 1
  v_max_u32_dpp v20, v20, v20 row_shr:1 row_mask:0xf bank_mask:0xf bound_ctrl:0
  s_nop 1
  v_max_u32_dpp v20, v20, v20 row_shr:2 row_mask:0xf bank_mask:0xf bound_ctrl:0
  s_nop 1
  v_max_u32_dpp v20, v20, v20 row_shr:4 row_mask:0xf bank_mask:0xf bound_ctrl:0
  s_nop 1
  v_max_u32_dpp v20, v20, v20 row_shr:8 row_mask:0xf bank_mask:0xf bound_ctrl:0
  s_nop 1
  v_max_u32_dpp v20, v20, v20 row_bcast:15 row_mask:0xa bank_mask:0xf
  s_nop 1
  v_max_u32_dpp v20, v20, v20 row_bcast:31 row_mask:0xc bank_mask:0xf
  s_nop 0
  v_readlane_b32 s50, v20, 63
  s_nop 1
  v_cmp_eq_u32 vcc, s50, v10
  v_writelane_b32 v30, s50, 1
  s_nop 0
  v_cndmask_b32 v10, v10, v11, vcc
  v_cndmask_b32 v11, v11, v12, vcc
  v_cndmask_b32 v12, v12, v13, vcc
  v_cndmask_b32 v13, v13, v14, vcc
  v_cndmask_b32 v14, v14, v15, vcc
  v_cndmask_b32 v15, v15, v16, vcc
  v_cndmask_b32 v16, v16, 0, vcc
  v_mov_b32 v20, v10
  s_nop 1
  v_max_u32_dpp v20, v20, v20 row_shr:1 row_mask:0xf bank_mask:0xf bound_ctrl:0
  s_nop 1
  v_max_u32_dpp v20, v20, v20 row_shr:2 row_mask:0xf bank_mask:0xf bound_ctrl:0
  s_nop 1
  v_max_u32_dpp v20, v20, v20 row_shr:4 row_mask:0xf bank_mask:0xf bound_ctrl:0
  s_nop 1
  v_max_u32_dpp v20, v20, v20 row_shr:8 row_mask:0xf bank_mask:0xf bound_ctrl:0
  s_nop 1
  v_max_u32_dpp v20, v20, v20 row_bcast:15 row_mask:0xa bank_mask:0xf
  s_nop 1
  v_max_u32_dpp v20, v20, v20 row_bcast:31 row_mask:0xc bank_mask:0xf
  s_nop 0
  v_readlane_b32 s50, v20, 63
  s_nop 1
  v_cmp_eq_u32 vcc, s50, v10
  v_writelane_b32 v30, s50, 2
  s_nop 0
  v_cndmask_b32 v10, v10, v11, vcc
  v_cndmask_b32 v11, v11, v12, vcc
  v_cndmask_b32 v12, v12, v13, vcc
  v_cndmask_b32 v13, v13, v14, vcc
  v_cndmask_b32 v14, v14, v15, vcc
  v_cndmask_b32 v15, v15, 0, vcc
  v_mov_b32 v20, v10
  s_nop 1
  v_max_u32_dpp v20, v20, v20 row_shr:1 row_mask:0xf bank_mask:0xf bound_ctrl:0
  s_nop 1
  v_max_u32_dpp v20, v20, v20 row_shr:2 row_mask:0xf bank_mask:0xf bound_ctrl:0
  s_nop 1
  v_max_u32_dpp v20, v20, v20 row_shr:4 row_mask:0xf bank_mask:0xf bound_ctrl:0
  s_nop 1
  v_max_u32_dpp v20, v20, v20 row_shr:8 row_mask:0xf bank_mask:0xf bound_ctrl:0
  s_nop 1
  v_max_u32_dpp v20, v20, v20 row_bcast:15 row_mask:0xa bank_mask:0xf
  s_nop 1
  v_max_u32_dpp v20, v20, v20 row_bcast:31 row_mask:0xc bank_mask:0xf
  s_nop 0
  v_readlane_b32 s50, v20, 63
  s_nop 1
  v_cmp_eq_u32 vcc, s50, v10
  v_writelane_b32 v30, s50, 3
  s_nop 0
  v_cndmask_b32 v10, v10, v11, vcc
  v_cndmask_b32 v11, v11, v12, vcc
  v_cndmask_b32 v12, v12, v13, vcc
  v_cndmask_b32 v13, v13, v14, vcc
  v_cndmask_b32 v14, v14, 0, vcc
  v_mov_b32 v20, v10
  s_nop 1
  v_max_u32_dpp v20, v20, v20 row_shr:1 row_mask:0xf bank_mask:0xf bound_ctrl:0
  s_nop 1
  v_max_u32_dpp v20, v20, v20 row_shr:2 row_mask:0xf bank_mask:0xf bound_ctrl:0
  s_nop 1
  v_max_u32_dpp v20, v20, v20 row_shr:4 row_mask:0xf bank_mask:0xf bound_ctrl:0
  s_nop 1
  v_max_u32_dpp v20, v20, v20 row_shr:8 row_mask:0xf bank_mask:0xf bound_ctrl:0
  s_nop 1
  v_max_u32_dpp v20, v20, v20 row_bcast:15 row_mask:0xa bank_mask:0xf
  s_nop 1
  v_max_u32_dpp v20, v20, v20 row_bcast:31 row_mask:0xc bank_mask:0xf
  s_nop 0
  v_readlane_b32 s50, v20, 63
  s_nop 1
  v_cmp_eq_u32 vcc, s50, v10
  v_writelane_b32 v30, s50, 4
  s_nop 0
  v_cndmask_b32 v10, v10, v11, vcc
  v_cndmask_b32 v11, v11, v12, vcc
  v_cndmask_b32 v12, v12, v13, vcc
  v_cndmask_b32 v13, v13, 0, vcc
  v_mov_b32 v20, v10
  s_nop 1
  v_max_u32_dpp v20, v20, v20 row_shr:1 row_mask:0xf bank_mask:0xf bound_ctrl:0
  s_nop 1
  v_max_u32_dpp v20, v20, v20 row_shr:2 row_mask:0xf bank_mask:0xf bound_ctrl:0
  s_nop 1
  v_max_u32_dpp v20, v20, v20 row_shr:4 row_mask:0xf bank_mask:0xf bound_ctrl:0
  s_nop 1
  v_max_u32_dpp v20, v20, v20 row_shr:8 row_mask:0xf bank_mask:0xf bound_ctrl:0
  s_nop 1
  v_max_u32_dpp v20, v20, v20 row_bcast:15 row_mask:0xa bank_mask:0xf
  s_nop 1
  v_max_u32_dpp v20, v20, v20 row_bcast:31 row_mask:0xc bank_mask:0xf
  s_nop 0
  v_readlane_b32 s50, v20, 63
  s_nop 1
  v_cmp_eq_u32 vcc, s50, v10
  v_writelane_b32 v30, s50, 5
  s_nop 0
  v_cndmask_b32 v10, v10, v11, vcc
  v_cndmask_b32 v11, v11, v12, vcc
  v_cndmask_b32 v12, v12, 0, vcc
  v_mov_b32 v20, v10
  s_nop 1
  v_max_u32_dpp v20, v20, v20 row_shr:1 row_mask:0xf bank_mask:0xf bound_ctrl:0
  s_nop 1
  v_max_u32_dpp v20, v20, v20 row_shr:2 row_mask:0xf bank_mask:0xf bound_ctrl:0
  s_nop 1
  v_max_u32_dpp v20, v20, v20 row_shr:4 row_mask:0xf bank_mask:0xf bound_ctrl:0
  s_nop 1
  v_max_u32_dpp v20, v20, v20 row_shr:8 row_mask:0xf bank_mask:0xf bound_ctrl:0
  s_nop 1
  v_max_u32_dpp v20, v20, v20 row_bcast:15 row_mask:0xa bank_mask:0xf
  s_nop 1
  v_max_u32_dpp v20, v20, v20 row_bcast:31 row_mask:0xc bank_mask:0xf
  s_nop 0
  v_readlane_b32 s50, v20, 63
  s_nop 1
  v_cmp_eq_u32 vcc, s50, v10
  v_writelane_b32 v30, s50, 6
  s_nop 0
  v_cndmask_b32 v10, v10, v11, vcc
  v_cndmask_b32 v11, v11, 0, vcc
  v_mov_b32 v20, v10
  s_nop 1
  v_max_u32_dpp v20, v20, v20 row_shr:1 row_mask:0xf bank_mask:0xf bound_ctrl:0
  s_nop 1
  v_max_u32_dpp v20, v20, v20 row_shr:2 row_mask:0xf bank_mask:0xf bound_ctrl:0
  s_nop 1
  v_max_u32_dpp v20, v20, v20 row_shr:4 row_mask:0xf bank_mask:0xf bound_ctrl:0
  s_nop 1
  v_max_u32_dpp v20, v20, v20 row_shr:8 row_mask:0xf bank_mask:0xf bound_ctrl:0
  s_nop 1
  v_max_u32_dpp v20, v20, v20 row_bcast:15 row_mask:0xa bank_mask:0xf
  s_nop 1
  v_max_u32_dpp v20, v20, v20 row_bcast:31 row_mask:0xc bank_mask:0xf
  s_nop 0
  v_readlane_b32 s50, v20, 63
  s_nop 1
  v_cmp_eq_u32 vcc, s50, v10
  v_writelane_b32 v30, s50, 7
  s_nop 0
  v_cndmask_b32 v10, v10, 0, vcc
k3_tk_skip:
  v_and_b32 v31, 63, v0
  v_lshrrev_b32 v32, 6, v0
  v_lshlrev_b32 v33, 3, v32
  v_add_u32 v33, v33, v31
  v_lshlrev_b32 v33, 2, v33
  v_cmp_gt_u32 s[42:43], 8, v31
  v_cmp_gt_u32 vcc, 256, v0
  s_nop 1
  s_and_b64 vcc, vcc, s[42:43]
  s_and_saveexec_b64 s[40:41], vcc
  ds_write_b32 v33, v30 offset:16384
  s_mov_b64 exec, s[40:41]
  s_waitcnt lgkmcnt(0)
  s_barrier
  v_and_b32 v34, 31, v0
  v_lshlrev_b32 v34, 2, v34
  ds_read_b32 v35, v34 offset:16384
  v_mov_b32 v36, 0
  ds_read_b128 v[40:43], v36 offset:16384
  ds_read_b128 v[44:47], v36 offset:16400
  ds_read_b128 v[48:51], v36 offset:16416
  ds_read_b128 v[52:55], v36 offset:16432
  ds_read_b128 v[56:59], v36 offset:16448
  ds_read_b128 v[60:63], v36 offset:16464
  ds_read_b128 v[64:67], v36 offset:16480
  ds_read_b128 v[68:71], v36 offset:16496
  s_waitcnt lgkmcnt(0)
  v_mov_b32 v37, 0
  v_cmp_gt_u32 vcc, v40, v35
  v_addc_co_u32 v37, vcc, 0, v37, vcc
  v_cmp_gt_u32 vcc, v41, v35
  v_addc_co_u32 v37, vcc, 0, v37, vcc
  v_cmp_gt_u32 vcc, v42, v35
  v_addc_co_u32 v37, vcc, 0, v37, vcc
  v_cmp_gt_u32 vcc, v43, v35
  v_addc_co_u32 v37, vcc, 0, v37, vcc
  v_cmp_gt_u32 vcc, v44, v35
  v_addc_co_u32 v37, vcc, 0, v37, vcc
  v_cmp_gt_u32 vcc, v45, v35
  v_addc_co_u32 v37, vcc, 0, v37, vcc
  v_cmp_gt_u32 vcc, v46, v35
  v_addc_co_u32 v37, vcc, 0, v37, vcc
  v_cmp_gt_u32 vcc, v47, v35
  v_addc_co_u32 v37, vcc, 0, v37, vcc
  v_cmp_gt_u32 vcc, v48, v35
  v_addc_co_u32 v37, vcc, 0, v37, vcc
  v_cmp_gt_u32 vcc, v49, v35
  v_addc_co_u32 v37, vcc, 0, v37, vcc
  v_cmp_gt_u32 vcc, v50, v35
  v_addc_co_u32 v37, vcc, 0, v37, vcc
  v_cmp_gt_u32 vcc, v51, v35
  v_addc_co_u32 v37, vcc, 0, v37, vcc
  v_cmp_gt_u32 vcc, v52, v35
  v_addc_co_u32 v37, vcc, 0, v37, vcc
  v_cmp_gt_u32 vcc, v53, v35
  v_addc_co_u32 v37, vcc, 0, v37, vcc
  v_cmp_gt_u32 vcc, v54, v35
  v_addc_co_u32 v37, vcc, 0, v37, vcc
  v_cmp_gt_u32 vcc, v55, v35
  v_addc_co_u32 v37, vcc, 0, v37, vcc
  v_cmp_gt_u32 vcc, v56, v35
  v_addc_co_u32 v37, vcc, 0, v37, vcc
  v_cmp_gt_u32 vcc, v57, v35
  v_addc_co_u32 v37, vcc, 0, v37, vcc
  v_cmp_gt_u32 vcc, v58, v35
  v_addc_co_u32 v37, vcc, 0, v37, vcc
  v_cmp_gt_u32 vcc, v59, v35
  v_addc_co_u32 v37, vcc, 0, v37, vcc
  v_cmp_gt_u32 vcc, v60, v35
  v_addc_co_u32 v37, vcc, 0, v37, vcc
  v_cmp_gt_u32 vcc, v61, v35
  v_addc_co_u32 v37, vcc, 0, v37, vcc
  v_cmp_gt_u32 vcc, v62, v35
  v_addc_co_u32 v37, vcc, 0, v37, vcc
  v_cmp_gt_u32 vcc, v63, v35
  v_addc_co_u32 v37, vcc, 0, v37, vcc
  v_cmp_gt_u32 vcc, v64, v35
  v_addc_co_u32 v37, vcc, 0, v37, vcc
  v_cmp_gt_u32 vcc, v65, v35
  v_addc_co_u32 v37, vcc, 0, v37, vcc
  v_cmp_gt_u32 vcc, v66, v35
  v_addc_co_u32 v37, vcc, 0, v37, vcc
  v_cmp_gt_u32 vcc, v67, v35
  v_addc_co_u32 v37, vcc, 0, v37, vcc
  v_cmp_gt_u32 vcc, v68, v35
  v_addc_co_u32 v37, vcc, 0, v37, vcc
  v_cmp_gt_u32 vcc, v69, v35
  v_addc_co_u32 v37, vcc, 0, v37, vcc
  v_cmp_gt_u32 vcc, v70, v35
  v_addc_co_u32 v37, vcc, 0, v37, vcc
  v_cmp_gt_u32 vcc, v71, v35
  v_addc_co_u32 v37, vcc, 0, v37, vcc
  v_cmp_gt_u32 s[42:43], 8, v37
  v_cmp_gt_u32 vcc, 32, v0
  s_nop 1
  s_and_b64 vcc, vcc, s[42:43]
  s_and_saveexec_b64 s[40:41], vcc
  v_lshlrev_b32 v38, 2, v37
  ds_write_b32 v38, v35 offset:16512
  s_mov_b64 exec, s[40:41]
  s_waitcnt lgkmcnt(0)
  s_barrier
  v_and_b32 v8, 7, v4
  v_lshlrev_b32 v8, 2, v8
  ds_read_b32 v9, v8 offset:16512
  s_waitcnt lgkmcnt(0)
  v_and_b32 v18, 0xffff, v9
  v_sub_u32 v18, 0xffff, v18
  s_movk_i32 s44, 1280
  v_mul_lo_u32 v19, v18, s44
  v_lshl_add_u32 v19, v6, 1, v19
  buffer_load_dwordx4 v[176:179], v19, s[20:23], 0 offen offset:0
  buffer_load_dwordx4 v[180:183], v19, s[20:23], 0 offen offset:64
  buffer_load_dwordx4 v[184:187], v19, s[20:23], 0 offen offset:128
  buffer_load_dwordx4 v[188:191], v19, s[20:23], 0 offen offset:192
  buffer_load_dwordx4 v[192:195], v19, s[20:23], 0 offen offset:256
  v_mov_b32 v40, 0
  v_mov_b32 v41, 0
  v_mov_b32 v42, 0
  v_mov_b32 v43, 0
  v_mov_b32 v44, 0
  v_mov_b32 v45, 0
  v_mov_b32 v46, 0
  v_mov_b32 v47, 0
  s_waitcnt vmcnt(0)
  v_mfma_f32_16x16x32_bf16 v[40:43], v[176:179], v[96:99], v[40:43]
  v_mfma_f32_16x16x32_bf16 v[44:47], v[176:179], v[100:103], v[44:47]
  v_mfma_f32_16x16x32_bf16 v[40:43], v[180:183], v[104:107], v[40:43]
  v_mfma_f32_16x16x32_bf16 v[44:47], v[180:183], v[108:111], v[44:47]
  v_mfma_f32_16x16x32_bf16 v[40:43], v[184:187], v[112:115], v[40:43]
  v_mfma_f32_16x16x32_bf16 v[44:47], v[184:187], v[116:119], v[44:47]
  v_mfma_f32_16x16x32_bf16 v[40:43], v[188:191], v[120:123], v[40:43]
  v_mfma_f32_16x16x32_bf16 v[44:47], v[188:191], v[124:127], v[44:47]
  v_mfma_f32_16x16x32_bf16 v[40:43], v[192:195], v[128:131], v[40:43]
  v_mfma_f32_16x16x32_bf16 v[44:47], v[192:195], v[132:135], v[44:47]
  s_nop 7
  v_lshlrev_b32 v24, 4, v2
  v_lshl_add_u32 v24, v3, 11, v24
  ds_write_b128 v24, v[40:43] offset:0
  ds_write_b128 v24, v[44:47] offset:1024
  s_waitcnt lgkmcnt(0)
  s_barrier
  v_cmp_gt_u32 vcc, 32, v0
  s_and_saveexec_b64 s[40:41], vcc
  s_cbranch_execz k3_skipgu
  v_lshlrev_b32 v24, 4, v0
  ds_read_b128 v[64:67], v24 offset:0
  ds_read_b128 v[68:71], v24 offset:1024
  ds_read_b128 v[72:75], v24 offset:2048
  ds_read_b128 v[76:79], v24 offset:3072
  ds_read_b128 v[80:83], v24 offset:4096
  ds_read_b128 v[84:87], v24 offset:5120
  ds_read_b128 v[88:91], v24 offset:6144
  ds_read_b128 v[92:95], v24 offset:7168
  ds_read_b128 v[96:99], v24 offset:8192
  ds_read_b128 v[100:103], v24 offset:9216
  ds_read_b128 v[104:107], v24 offset:10240
  ds_read_b128 v[108:111], v24 offset:11264
  ds_read_b128 v[112:115], v24 offset:12288
  ds_read_b128 v[116:119], v24 offset:13312
  ds_read_b128 v[120:123], v24 offset:14336
  ds_read_b128 v[124:127], v24 offset:15360
  s_waitcnt lgkmcnt(0)
  v_add_f32 v64, v64, v72
  v_add_f32 v80, v80, v88
  v_add_f32 v96, v96, v104
  v_add_f32 v112, v112, v120
  v_add_f32 v65, v65, v73
  v_add_f32 v81, v81, v89
  v_add_f32 v97, v97, v105
  v_add_f32 v113, v113, v121
  v_add_f32 v66, v66, v74
  v_add_f32 v82, v82, v90
  v_add_f32 v98, v98, v106
  v_add_f32 v114, v114, v122
  v_add_f32 v67, v67, v75
  v_add_f32 v83, v83, v91
  v_add_f32 v99, v99, v107
  v_add_f32 v115, v115, v123
  v_add_f32 v68, v68, v76
  v_add_f32 v84, v84, v92
  v_add_f32 v100, v100, v108
  v_add_f32 v116, v116, v124
  v_add_f32 v69, v69, v77
  v_add_f32 v85, v85, v93
  v_add_f32 v101, v101, v109
  v_add_f32 v117, v117, v125
  v_add_f32 v70, v70, v78
  v_add_f32 v86, v86, v94
  v_add_f32 v102, v102, v110
  v_add_f32 v118, v118, v126
  v_add_f32 v71, v71, v79
  v_add_f32 v87, v87, v95
  v_add_f32 v103, v103, v111
  v_add_f32 v119, v119, v127
  v_add_f32 v64, v64, v80
  v_add_f32 v72, v96, v112
  v_add_f32 v65, v65, v81
  v_add_f32 v73, v97, v113
  v_add_f32 v66, v66, v82
  v_add_f32 v74, v98, v114
  v_add_f32 v67, v67, v83
  v_add_f32 v75, v99, v115
  v_add_f32 v68, v68, v84
  v_add_f32 v76, v100, v116
  v_add_f32 v69, v69, v85
  v_add_f32 v77, v101, v117
  v_add_f32 v70, v70, v86
  v_add_f32 v78, v102, v118
  v_add_f32 v71, v71, v87
  v_add_f32 v79, v103, v119
  v_cvt_pk_bf16_f32 v130, v64, v65
  v_lshlrev_b32 v64, 16, v130
  v_and_b32 v65, 0xffff0000, v130
  v_cvt_pk_bf16_f32 v130, v66, v67
  v_lshlrev_b32 v66, 16, v130
  v_and_b32 v67, 0xffff0000, v130
  v_cvt_pk_bf16_f32 v130, v68, v69
  v_lshlrev_b32 v68, 16, v130
  v_and_b32 v69, 0xffff0000, v130
  v_cvt_pk_bf16_f32 v130, v70, v71
  v_lshlrev_b32 v70, 16, v130
  v_and_b32 v71, 0xffff0000, v130
  v_cvt_pk_bf16_f32 v130, v72, v73
  v_lshlrev_b32 v72, 16, v130
  v_and_b32 v73, 0xffff0000, v130
  v_cvt_pk_bf16_f32 v130, v74, v75
  v_lshlrev_b32 v74, 16, v130
  v_and_b32 v75, 0xffff0000, v130
  v_cvt_pk_bf16_f32 v130, v76, v77
  v_lshlrev_b32 v76, 16, v130
  v_and_b32 v77, 0xffff0000, v130
  v_cvt_pk_bf16_f32 v130, v78, v79
  v_lshlrev_b32 v78, 16, v130
  v_and_b32 v79, 0xffff0000, v130
  v_mul_f32 v80, 0xbfb8aa3b, v64
  v_mul_f32 v81, 0xbfb8aa3b, v65
  v_mul_f32 v82, 0xbfb8aa3b, v66
  v_mul_f32 v83, 0xbfb8aa3b, v67
  v_mul_f32 v84, 0xbfb8aa3b, v68
  v_mul_f32 v85, 0xbfb8aa3b, v69
  v_mul_f32 v86, 0xbfb8aa3b, v70
  v_mul_f32 v87, 0xbfb8aa3b, v71
  v_exp_f32 v80, v80
  v_exp_f32 v81, v81
  v_exp_f32 v82, v82
  v_exp_f32 v83, v83
  v_exp_f32 v84, v84
  v_exp_f32 v85, v85
  v_exp_f32 v86, v86
  v_exp_f32 v87, v87
  s_nop 0
  v_add_f32 v80, 1.0, v80
  v_add_f32 v81, 1.0, v81
  v_add_f32 v82, 1.0, v82
  v_add_f32 v83, 1.0, v83
  v_add_f32 v84, 1.0, v84
  v_add_f32 v85, 1.0, v85
  v_add_f32 v86, 1.0, v86
  v_add_f32 v87, 1.0, v87
  v_rcp_f32 v80, v80
  v_rcp_f32 v81, v81
  v_rcp_f32 v82, v82
  v_rcp_f32 v83, v83
  v_rcp_f32 v84, v84
  v_rcp_f32 v85, v85
  v_rcp_f32 v86, v86
  v_rcp_f32 v87, v87
  s_nop 0
  v_mul_f32 v80, v64, v80
  v_mul_f32 v81, v65, v81
  v_mul_f32 v82, v66, v82
  v_mul_f32 v83, v67, v83
  v_mul_f32 v84, v68, v84
  v_mul_f32 v85, v69, v85
  v_mul_f32 v86, v70, v86
  v_mul_f32 v87, v71, v87
  v_cvt_pk_bf16_f32 v130, v80, v81
  v_lshlrev_b32 v80, 16, v130
  v_and_b32 v81, 0xffff0000, v130
  v_cvt_pk_bf16_f32 v130, v82, v83
  v_lshlrev_b32 v82, 16, v130
  v_and_b32 v83, 0xffff0000, v130
  v_cvt_pk_bf16_f32 v130, v84, v85
  v_lshlrev_b32 v84, 16, v130
  v_and_b32 v85, 0xffff0000, v130
  v_cvt_pk_bf16_f32 v130, v86, v87
  v_lshlrev_b32 v86, 16, v130
  v_and_b32 v87, 0xffff0000, v130
  v_mul_f32 v80, v80, v72
  v_mul_f32 v81, v81, v73
  v_mul_f32 v82, v82, v74
  v_mul_f32 v83, v83, v75
  v_mul_f32 v84, v84, v76
  v_mul_f32 v85, v85, v77
  v_mul_f32 v86, v86, v78
  v_mul_f32 v87, v87, v79
  v_lshlrev_b32 v25, 8, v5
  v_lshl_add_u32 v25, v4, 2, v25
  s_lshl_b32 s47, s2, 9
  v_cvt_pk_bf16_f32 v90, v80, v84
  buffer_store_dword v90, v25, s[32:35], s47 offen offset:0 sc1
  v_cvt_pk_bf16_f32 v91, v81, v85
  buffer_store_dword v91, v25, s[32:35], s47 offen offset:64 sc1
  v_cvt_pk_bf16_f32 v92, v82, v86
  buffer_store_dword v92, v25, s[32:35], s47 offen offset:128 sc1
  v_cvt_pk_bf16_f32 v93, v83, v87
  buffer_store_dword v93, v25, s[32:35], s47 offen offset:192 sc1
  s_waitcnt vmcnt(0)
  v_cmp_eq_u32 vcc, 0, v0
  s_and_saveexec_b64 s[42:43], vcc
  v_mov_b32 v28, 1
  v_mov_b32 v29, 0
  buffer_atomic_add v28, v29, s[64:67], 0 offen
  s_cmp_ge_u32 s2, 40
  s_cbranch_scc1 k3_skipgu
k3_poll:
  buffer_load_dword v28, v29, s[64:67], 0 offen sc1
  s_waitcnt vmcnt(0)
  v_readfirstlane_b32 s47, v28
  s_nop 3
  s_cmp_ge_u32 s47, 54
  s_cbranch_scc1 k3_skipgu
  s_sleep 1
  s_branch k3_poll
k3_skipgu:
  s_mov_b64 exec, s[40:41]
  s_cmp_ge_u32 s2, 40
  s_cbranch_scc1 k3_fin
  s_barrier
  v_and_b32 v8, 7, v4
  v_lshlrev_b32 v8, 6, v8
  v_lshl_add_u32 v8, v5, 4, v8
  s_lshl_b32 s47, s68, 9
  buffer_load_dwordx4 v[96:99], v8, s[32:35], s47 offen offset:0 sc1
  s_add_u32 s47, s47, 4096
  buffer_load_dwordx4 v[100:103], v8, s[32:35], s47 offen offset:0 sc1
  s_add_u32 s47, s47, 4096
  buffer_load_dwordx4 v[104:107], v8, s[32:35], s47 offen offset:0 sc1
  s_add_u32 s47, s47, 4096
  buffer_load_dwordx4 v[108:111], v8, s[32:35], s47 offen offset:0 sc1
  s_add_u32 s47, s47, 4096
  buffer_load_dwordx4 v[112:115], v8, s[32:35], s47 offen offset:0 sc1
  s_add_u32 s47, s47, 4096
  buffer_load_dwordx4 v[116:119], v8, s[32:35], s47 offen offset:0 sc1
  s_add_u32 s47, s47, 4096
  buffer_load_dwordx4 v[120:123], v8, s[32:35], s47 offen offset:0 sc1
  v_mov_b32 v40, 0
  v_mov_b32 v41, 0
  v_mov_b32 v42, 0
  v_mov_b32 v43, 0
  s_waitcnt vmcnt(6)
  v_mfma_f32_16x16x32_bf16 v[40:43], v[96:99], v[136:139], v[40:43]
  s_waitcnt vmcnt(5)
  v_mfma_f32_16x16x32_bf16 v[40:43], v[100:103], v[140:143], v[40:43]
  s_waitcnt vmcnt(4)
  v_mfma_f32_16x16x32_bf16 v[40:43], v[104:107], v[144:147], v[40:43]
  s_waitcnt vmcnt(3)
  v_mfma_f32_16x16x32_bf16 v[40:43], v[108:111], v[148:151], v[40:43]
  s_waitcnt vmcnt(2)
  v_mfma_f32_16x16x32_bf16 v[40:43], v[112:115], v[152:155], v[40:43]
  s_waitcnt vmcnt(1)
  v_mfma_f32_16x16x32_bf16 v[40:43], v[116:119], v[156:159], v[40:43]
  s_waitcnt vmcnt(0)
  v_mfma_f32_16x16x32_bf16 v[40:43], v[120:123], v[160:163], v[40:43]
  s_nop 7
  v_lshlrev_b32 v24, 4, v2
  v_lshl_add_u32 v24, v3, 10, v24
  ds_write_b128 v24, v[40:43]
  s_waitcnt lgkmcnt(0)
  s_barrier
  v_cmp_gt_u32 vcc, 32, v0
  s_and_saveexec_b64 s[40:41], vcc
  s_cbranch_execz k3_fin
  v_lshlrev_b32 v24, 4, v0
  ds_read_b128 v[96:99], v24 offset:0
  ds_read_b128 v[100:103], v24 offset:1024
  ds_read_b128 v[104:107], v24 offset:2048
  ds_read_b128 v[108:111], v24 offset:3072
  ds_read_b128 v[112:115], v24 offset:4096
  ds_read_b128 v[116:119], v24 offset:5120
  ds_read_b128 v[120:123], v24 offset:6144
  ds_read_b128 v[124:127], v24 offset:7168
  v_lshlrev_b32 v31, 4, v5
  ds_read_b128 v[44:47], v31 offset:16512
  s_waitcnt lgkmcnt(0)
  s_lshr_b32 s47, s2, 2
  s_lshl_b32 s47, s47, 6
  s_and_b32 s48, s2, 3
  s_add_u32 s47, s47, s48
  s_lshl_b32 s47, s47, 1
  s_movk_i32 s44, 1280
  v_and_b32 v48, 0xffff, v44
  v_sub_u32 v48, 0xffff, v48
  v_mul_lo_u32 v48, v48, s44
  v_lshl_add_u32 v48, v4, 3, v48
  buffer_load_ushort v52, v48, s[56:59], s47 offen
  buffer_load_ushort v56, v48, s[20:23], s47 offen
  v_and_b32 v49, 0xffff, v45
  v_sub_u32 v49, 0xffff, v49
  v_mul_lo_u32 v49, v49, s44
  v_lshl_add_u32 v49, v4, 3, v49
  buffer_load_ushort v53, v49, s[56:59], s47 offen
  buffer_load_ushort v57, v49, s[20:23], s47 offen
  v_and_b32 v50, 0xffff, v46
  v_sub_u32 v50, 0xffff, v50
  v_mul_lo_u32 v50, v50, s44
  v_lshl_add_u32 v50, v4, 3, v50
  buffer_load_ushort v54, v50, s[56:59], s47 offen
  buffer_load_ushort v58, v50, s[20:23], s47 offen
  v_and_b32 v51, 0xffff, v47
  v_sub_u32 v51, 0xffff, v51
  v_mul_lo_u32 v51, v51, s44
  v_lshl_add_u32 v51, v4, 3, v51
  buffer_load_ushort v55, v51, s[56:59], s47 offen
  buffer_load_ushort v59, v51, s[20:23], s47 offen
  v_and_b32 v20, 0xffff0000, v44
  v_ashrrev_i32 v21, 31, v20
  v_not_b32 v21, v21
  v_or_b32 v21, 0x80000000, v21
  v_xor_b32 v20, v20, v21
  v_and_b32 v20, 0xffff0000, v20
  v_mul_f32 v60, 0xbfb8aa3b, v20
  v_and_b32 v20, 0xffff0000, v45
  v_ashrrev_i32 v21, 31, v20
  v_not_b32 v21, v21
  v_or_b32 v21, 0x80000000, v21
  v_xor_b32 v20, v20, v21
  v_and_b32 v20, 0xffff0000, v20
  v_mul_f32 v61, 0xbfb8aa3b, v20
  v_and_b32 v20, 0xffff0000, v46
  v_ashrrev_i32 v21, 31, v20
  v_not_b32 v21, v21
  v_or_b32 v21, 0x80000000, v21
  v_xor_b32 v20, v20, v21
  v_and_b32 v20, 0xffff0000, v20
  v_mul_f32 v62, 0xbfb8aa3b, v20
  v_and_b32 v20, 0xffff0000, v47
  v_ashrrev_i32 v21, 31, v20
  v_not_b32 v21, v21
  v_or_b32 v21, 0x80000000, v21
  v_xor_b32 v20, v20, v21
  v_and_b32 v20, 0xffff0000, v20
  v_mul_f32 v63, 0xbfb8aa3b, v20
  v_exp_f32 v60, v60
  v_exp_f32 v61, v61
  v_exp_f32 v62, v62
  v_exp_f32 v63, v63
  s_nop 0
  v_add_f32 v60, 1.0, v60
  v_add_f32 v61, 1.0, v61
  v_add_f32 v62, 1.0, v62
  v_add_f32 v63, 1.0, v63
  v_rcp_f32 v60, v60
  v_rcp_f32 v61, v61
  v_rcp_f32 v62, v62
  v_rcp_f32 v63, v63
  s_nop 0
  v_cvt_pk_bf16_f32 v64, v60, v61
  v_lshlrev_b32 v60, 16, v64
  v_and_b32 v61, 0xffff0000, v64
  v_cvt_pk_bf16_f32 v64, v62, v63
  v_lshlrev_b32 v62, 16, v64
  v_and_b32 v63, 0xffff0000, v64
  v_add_f32 v96, v96, v100
  v_add_f32 v97, v97, v101
  v_add_f32 v98, v98, v102
  v_add_f32 v99, v99, v103
  v_add_f32 v96, v96, v104
  v_add_f32 v97, v97, v105
  v_add_f32 v98, v98, v106
  v_add_f32 v99, v99, v107
  v_add_f32 v96, v96, v108
  v_add_f32 v97, v97, v109
  v_add_f32 v98, v98, v110
  v_add_f32 v99, v99, v111
  v_add_f32 v96, v96, v112
  v_add_f32 v97, v97, v113
  v_add_f32 v98, v98, v114
  v_add_f32 v99, v99, v115
  v_add_f32 v96, v96, v116
  v_add_f32 v97, v97, v117
  v_add_f32 v98, v98, v118
  v_add_f32 v99, v99, v119
  v_add_f32 v96, v96, v120
  v_add_f32 v97, v97, v121
  v_add_f32 v98, v98, v122
  v_add_f32 v99, v99, v123
  v_add_f32 v96, v96, v124
  v_add_f32 v97, v97, v125
  v_add_f32 v98, v98, v126
  v_add_f32 v99, v99, v127
  v_cvt_pk_bf16_f32 v64, v96, v97
  v_lshlrev_b32 v96, 16, v64
  v_and_b32 v97, 0xffff0000, v64
  v_cvt_pk_bf16_f32 v64, v98, v99
  v_lshlrev_b32 v98, 16, v64
  v_and_b32 v99, 0xffff0000, v64
  v_mul_f32 v96, v96, v60
  v_mul_f32 v97, v97, v61
  v_mul_f32 v98, v98, v62
  v_mul_f32 v99, v99, v63
  v_cvt_pk_bf16_f32 v64, v96, v97
  v_lshlrev_b32 v96, 16, v64
  v_and_b32 v97, 0xffff0000, v64
  v_cvt_pk_bf16_f32 v64, v98, v99
  v_lshlrev_b32 v98, 16, v64
  v_and_b32 v99, 0xffff0000, v64
  s_waitcnt vmcnt(0)
  v_lshlrev_b32 v56, 16, v56
  v_lshlrev_b32 v52, 16, v52
  v_add_f32 v96, v96, v56
  v_lshlrev_b32 v57, 16, v57
  v_lshlrev_b32 v53, 16, v53
  v_add_f32 v97, v97, v57
  v_lshlrev_b32 v58, 16, v58
  v_lshlrev_b32 v54, 16, v54
  v_add_f32 v98, v98, v58
  v_lshlrev_b32 v59, 16, v59
  v_lshlrev_b32 v55, 16, v55
  v_add_f32 v99, v99, v59
  v_cvt_pk_bf16_f32 v64, v96, v97
  v_lshlrev_b32 v96, 16, v64
  v_and_b32 v97, 0xffff0000, v64
  v_cvt_pk_bf16_f32 v64, v98, v99
  v_lshlrev_b32 v98, 16, v64
  v_and_b32 v99, 0xffff0000, v64
  v_add_f32 v96, v96, v52
  v_cvt_pk_bf16_f32 v96, v96, v96
  buffer_store_short v96, v48, s[60:63], s47 offen
  v_add_f32 v97, v97, v53
  v_cvt_pk_bf16_f32 v97, v97, v97
  buffer_store_short v97, v49, s[60:63], s47 offen
  v_add_f32 v98, v98, v54
  v_cvt_pk_bf16_f32 v98, v98, v98
  buffer_store_short v98, v50, s[60:63], s47 offen
  v_add_f32 v99, v99, v55
  v_cvt_pk_bf16_f32 v99, v99, v99
  buffer_store_short v99, v51, s[60:63], s47 offen
k3_fin:
k3_done:
  s_endpgm
.section .rodata,"a"
.p2align 6
.amdhsa_kernel k0_kernel
  .amdhsa_next_free_vgpr 152
  .amdhsa_next_free_sgpr 102
  .amdhsa_accum_offset 152
  .amdhsa_group_segment_fixed_size 0
  .amdhsa_kernarg_size 112
  .amdhsa_user_sgpr_count 2
  .amdhsa_user_sgpr_kernarg_segment_ptr 1
  .amdhsa_system_sgpr_workgroup_id_x 1
.end_amdhsa_kernel
.p2align 6
.amdhsa_kernel k1_kernel
  .amdhsa_next_free_vgpr 168
  .amdhsa_next_free_sgpr 102
  .amdhsa_accum_offset 168
  .amdhsa_group_segment_fixed_size 0
  .amdhsa_kernarg_size 112
  .amdhsa_user_sgpr_count 2
  .amdhsa_user_sgpr_kernarg_segment_ptr 1
  .amdhsa_system_sgpr_workgroup_id_x 1
.end_amdhsa_kernel
.p2align 6
.amdhsa_kernel k2_kernel
  .amdhsa_next_free_vgpr 96
  .amdhsa_next_free_sgpr 102
  .amdhsa_accum_offset 96
  .amdhsa_group_segment_fixed_size 0
  .amdhsa_kernarg_size 112
  .amdhsa_user_sgpr_count 2
  .amdhsa_user_sgpr_kernarg_segment_ptr 1
  .amdhsa_system_sgpr_workgroup_id_x 1
.end_amdhsa_kernel
.p2align 6
.amdhsa_kernel k3_kernel
  .amdhsa_next_free_vgpr 256
  .amdhsa_next_free_sgpr 102
  .amdhsa_accum_offset 256
  .amdhsa_group_segment_fixed_size 0
  .amdhsa_kernarg_size 112
  .amdhsa_user_sgpr_count 2
  .amdhsa_user_sgpr_kernarg_segment_ptr 1
  .amdhsa_system_sgpr_workgroup_id_x 1
.end_amdhsa_kernel
```
